```python
import torch

def _softmax(x, axis=-1):
    return torch.softmax(x, dim=axis)
def _gelu(x):
    return torch.nn.functional.gelu(x, approximate="tanh")
def _silu(x):
    return torch.nn.functional.silu(x)
def _sigmoid(x):
    return torch.sigmoid(x)
def _layernorm(x, axis=-1, eps=1e-5):
    m = x.mean(dim=axis, keepdim=True)
    v = x.var(dim=axis, keepdim=True, unbiased=False)
    return (x - m) / torch.sqrt(v + eps)
def _scatter_add(tgt, idx, src, axis=0):
    return tgt.clone().index_add_(axis, idx, src)
def _segment_sum(src, seg, n):
    out = torch.zeros((n,) + src.shape[1:], dtype=src.dtype)
    return out.index_add_(0, seg, src)
def _pad(x, pw):
    flat = tuple(v for pair in reversed(pw) for v in pair)
    return torch.nn.functional.pad(x, flat)

kernel_name = 'gated_mix__spectral_gfnet__ssm_conv_s5__prompt'

def setup_inputs():

    _w = (lambda a: (lambda t: t.to(torch.bfloat16) if t.is_floating_point() else t)(torch.as_tensor(a)))
    def _A_setup():
        B, S, D = 1, 2048, 640
        Df = D // 2 + 1
        return {
            "x": _w((lambda *s: torch.randn(*s, dtype=torch.bfloat16) * 0.05)(B, S, D)),
            "w_r": _w((lambda *s: torch.randn(*s, dtype=torch.bfloat16) * 0.8)(S, Df) * 0.02),
            "w_i": _w((lambda *s: torch.randn(*s, dtype=torch.bfloat16) * 0.8)(S, Df) * 0.02),
        }
    _A_in = _A_setup()

    def _B_setup():
        B, S, D = 1, 2048, 640
        P = D
        Lambda_re = -0.5 * (lambda _x: torch.exp(torch.as_tensor(_x)))((lambda *s: torch.randn(*s, dtype=torch.bfloat16) * 0.2)(P))
        Lambda_im = (lambda *s: torch.randn(*s, dtype=torch.bfloat16) * 0.2)(P) * 1.0
        B_re = (lambda *s: torch.randn(*s, dtype=torch.bfloat16) * 0.2)(P, D) * (D ** -0.5)
        B_im = (lambda *s: torch.randn(*s, dtype=torch.bfloat16) * 0.2)(P, D) * (D ** -0.5)
        C_re = (lambda *s: torch.randn(*s, dtype=torch.bfloat16) * 0.2)(D, P) * (P ** -0.5)
        C_im = (lambda *s: torch.randn(*s, dtype=torch.bfloat16) * 0.2)(D, P) * (P ** -0.5)
        log_dt = (lambda *s: torch.randn(*s, dtype=torch.bfloat16) * 0.2)(P) * 0.3 - 2.0
        Dskip = (lambda *s: torch.randn(*s, dtype=torch.bfloat16) * 0.05)(D)
        return {
            "x": _w((lambda *s: torch.randn(*s, dtype=torch.bfloat16) * 0.05)(B, S, D)),
            "Lambda_re": _w(Lambda_re),
            "Lambda_im": _w(Lambda_im),
            "B_re": _w(B_re),
            "B_im": _w(B_im),
            "C_re": _w(C_re),
            "C_im": _w(C_im),
            "log_dt": _w(log_dt),
            "Dskip": _w(Dskip),
        }
    _B_in = _B_setup()

    return {
        "A_x": _A_in["x"],
        "A_w_r": _A_in["w_r"],
        "A_w_i": _A_in["w_i"],
        "B_x": _B_in["x"],
        "B_Lambda_re": _B_in["Lambda_re"],
        "B_Lambda_im": _B_in["Lambda_im"],
        "B_B_re": _B_in["B_re"],
        "B_B_im": _B_in["B_im"],
        "B_C_re": _B_in["C_re"],
        "B_C_im": _B_in["C_im"],
        "B_log_dt": _B_in["log_dt"],
        "B_Dskip": _B_in["Dskip"],
        "gate_w": _w((lambda *s: torch.randn(*s, dtype=torch.bfloat16) * 0.05)(640) * 16.0),
    }

def reference(A_x, A_w_r, A_w_i, B_x, B_Lambda_re, B_Lambda_im, B_B_re, B_B_im, B_C_re, B_C_im, B_log_dt, B_Dskip, gate_w):
    def _A_ref(x, w_r, w_i):
        B, S, D = x.shape
        X = (lambda x, axes=(-2,-1): torch.fft.rfft2(x.float(), dim=axes))(x, axes=(-2, -1))
        W = w_r + 1j * w_i
        X = X * W
        y = (lambda x, s, axes=(-2,-1): torch.fft.irfft2(x, s=s, dim=axes).to(torch.bfloat16))(X, (S, D), axes=(-2, -1))
        return y

    def _B_ref(x, Lambda_re, Lambda_im, B_re, B_im, C_re, C_im, log_dt, Dskip):
        Bsz, L, H = x.shape
        Lam = Lambda_re + 1j * Lambda_im
        Bmat = B_re + 1j * B_im
        Cmat = C_re + 1j * C_im
        dt = torch.exp(log_dt)
        Lam_bar = torch.exp(dt * Lam)
        B_bar = ((Lam_bar - 1.0) / Lam)[:, None] * Bmat
        Bu = torch.einsum("bld,pd->blp", x + 0j, B_bar)
        h = torch.zeros_like(Bu[:, 0, :])
        hs = []
        for t in range(L):
            h = Lam_bar[None, :] * h + Bu[:, t, :]
            hs.append(h)
        hseq = torch.stack(hs, 1)
        y = 2.0 * torch.einsum("blp,dp->bld", hseq, Cmat).real + x * Dskip[None, None, :]
        return y

    x = A_x
    g = _sigmoid((x * gate_w).sum(-1, keepdims=True))
    a = _A_ref(x, A_w_r, A_w_i)
    b = _B_ref(x, B_Lambda_re, B_Lambda_im, B_B_re, B_B_im, B_C_re, B_C_im, B_log_dt, B_Dskip)
    return g * a + (1 - g) * b
```

```asm
; @launch kernel=gated_mix__spectral_gfnet__ssm_conv_s5__prompt_kernel grid=(256,1,1) block=(512,1,1) lds=163840
.amdgcn_target "amdgcn-amd-amdhsa--gfx950"
.text
.globl gated_mix__spectral_gfnet__ssm_conv_s5__prompt_kernel
.p2align 8
.type gated_mix__spectral_gfnet__ssm_conv_s5__prompt_kernel,@function
gated_mix__spectral_gfnet__ssm_conv_s5__prompt_kernel:
    s_load_dwordx16 s[16:31], s[0:1], 0
    s_load_dwordx16 s[32:47], s[0:1], 64
    s_cmp_ge_u32 s2, 256
    s_cbranch_scc1 L_exit
    v_lshrrev_b32 v1, 6, v0
    v_and_b32 v0, 63, v0
    v_readfirstlane_b32 s3, v1
    s_and_b32 s4, s2, 7
    s_lshr_b32 s5, s2, 3
    s_cmp_lt_u32 s5, 20
    s_cbranch_scc1 L_B
    s_cmp_lt_u32 s5, 28
    s_cbranch_scc1 L_A
    s_branch L_W
L_exit:
    s_endpgm
L_B:
    s_and_b32 s6, s5, 1
    s_lshr_b32 s9, s5, 1
    s_lshl1_add_u32 s8, s4, s6
    s_cmp_ge_u32 s3, 4
    s_cbranch_scc0 L_Bc
    s_sub_u32 s10, s3, 4
    s_mul_i32 s11, s6, 5
    s_add_u32 s11, s11, s9
    s_add_u32 s11, s11, s4
    s_sub_u32 s12, s11, 10
    s_cmp_ge_u32 s11, 10
    s_cselect_b32 s11, s12, s11
    s_sub_u32 s12, s11, 10
    s_cmp_ge_u32 s11, 10
    s_cselect_b32 s11, s12, s11
    s_lshl_b32 s11, s11, 7
    s_lshl1_add_u32 s12, s8, s10
    s_cmp_lt_u32 s10, 2
    s_cselect_b32 s12, s12, s9
    s_mul_i32 s12, s12, 81920
    v_lshrrev_b32 v2, 3, v0
    v_mul_u32_u24 v2, 1280, v2
    v_lshrrev_b32 v3, 4, v0
    v_and_b32 v4, 7, v0
    v_xor_b32 v4, v4, v3
    v_xor_b32 v5, 4, v4
    v_lshl_add_u32 v4, v4, 4, v2
    v_lshl_add_u32 v5, v5, 4, v2
    v_add_u32 v8, 0, v4
    v_add_u32 v9, 9216, v5
    v_add_u32 v10, 18432, v4
    v_add_u32 v11, 27648, v5
    v_add_u32 v12, 40960, v4
    v_add_u32 v13, 50176, v5
    v_add_u32 v14, 59392, v4
    v_add_u32 v15, 68608, v5
    s_lshl_b32 s13, s10, 13
    s_waitcnt lgkmcnt(0)
    s_cmp_eq_u32 s10, 2
    s_cselect_b32 s48, s28, s30
    s_cselect_b32 s49, s29, s31
    s_cmp_lt_u32 s10, 2
    s_cselect_b32 s48, s16, s48
    s_cselect_b32 s49, s17, s49
    s_mov_b32 s50, 819200
    s_cselect_b32 s50, 2621440, s50
    s_mov_b32 s51, 0x20000
    s_add_u32 s14, s12, s11
    s_add_u32 m0, s13, 0
    s_nop 0
    buffer_load_dwordx4 v8, s[48:51], s14 offen offset:0 lds
    buffer_load_dwordx4 v9, s[48:51], s14 offen offset:1024 lds
    buffer_load_dwordx4 v10, s[48:51], s14 offen offset:2048 lds
    buffer_load_dwordx4 v11, s[48:51], s14 offen offset:3072 lds
    s_add_u32 m0, s13, 4096
    s_nop 0
    buffer_load_dwordx4 v12, s[48:51], s14 offen offset:0 lds
    buffer_load_dwordx4 v13, s[48:51], s14 offen offset:1024 lds
    buffer_load_dwordx4 v14, s[48:51], s14 offen offset:2048 lds
    buffer_load_dwordx4 v15, s[48:51], s14 offen offset:3072 lds
    s_add_u32 s11, s11, 128
    s_cmp_eq_u32 s11, 1280
    s_cselect_b32 s11, 0, s11
    s_waitcnt lgkmcnt(0)
    s_load_dword s68, s[46:47], 40960
    s_mov_b32 s56, s46
    s_mov_b32 s57, s47
    s_mov_b32 s58, 13336576
    s_mov_b32 s59, 0x20000
    s_add_u32 s14, s12, s11
    s_add_u32 m0, s13, 32768
    s_nop 0
    buffer_load_dwordx4 v8, s[48:51], s14 offen offset:0 lds
    buffer_load_dwordx4 v9, s[48:51], s14 offen offset:1024 lds
    buffer_load_dwordx4 v10, s[48:51], s14 offen offset:2048 lds
    buffer_load_dwordx4 v11, s[48:51], s14 offen offset:3072 lds
    s_add_u32 m0, s13, 36864
    s_nop 0
    buffer_load_dwordx4 v12, s[48:51], s14 offen offset:0 lds
    buffer_load_dwordx4 v13, s[48:51], s14 offen offset:1024 lds
    buffer_load_dwordx4 v14, s[48:51], s14 offen offset:2048 lds
    buffer_load_dwordx4 v15, s[48:51], s14 offen offset:3072 lds
    s_add_u32 s11, s11, 128
    s_cmp_eq_u32 s11, 1280
    s_cselect_b32 s11, 0, s11
    s_waitcnt lgkmcnt(0)
    s_add_u32 s68, s68, 1
    s_waitcnt vmcnt(8)
    s_barrier
    s_add_u32 s14, s12, s11
    s_add_u32 m0, s13, 65536
    s_nop 0
    buffer_load_dwordx4 v8, s[48:51], s14 offen offset:0 lds
    buffer_load_dwordx4 v9, s[48:51], s14 offen offset:1024 lds
    buffer_load_dwordx4 v10, s[48:51], s14 offen offset:2048 lds
    buffer_load_dwordx4 v11, s[48:51], s14 offen offset:3072 lds
    s_add_u32 m0, s13, 69632
    s_nop 0
    buffer_load_dwordx4 v12, s[48:51], s14 offen offset:0 lds
    buffer_load_dwordx4 v13, s[48:51], s14 offen offset:1024 lds
    buffer_load_dwordx4 v14, s[48:51], s14 offen offset:2048 lds
    buffer_load_dwordx4 v15, s[48:51], s14 offen offset:3072 lds
    s_add_u32 s11, s11, 128
    s_cmp_eq_u32 s11, 1280
    s_cselect_b32 s11, 0, s11
    s_waitcnt vmcnt(8)
    s_barrier
    s_add_u32 s14, s12, s11
    s_add_u32 m0, s13, 98304
    s_nop 0
    buffer_load_dwordx4 v8, s[48:51], s14 offen offset:0 lds
    buffer_load_dwordx4 v9, s[48:51], s14 offen offset:1024 lds
    buffer_load_dwordx4 v10, s[48:51], s14 offen offset:2048 lds
    buffer_load_dwordx4 v11, s[48:51], s14 offen offset:3072 lds
    s_add_u32 m0, s13, 102400
    s_nop 0
    buffer_load_dwordx4 v12, s[48:51], s14 offen offset:0 lds
    buffer_load_dwordx4 v13, s[48:51], s14 offen offset:1024 lds
    buffer_load_dwordx4 v14, s[48:51], s14 offen offset:2048 lds
    buffer_load_dwordx4 v15, s[48:51], s14 offen offset:3072 lds
    s_add_u32 s11, s11, 128
    s_cmp_eq_u32 s11, 1280
    s_cselect_b32 s11, 0, s11
    s_add_u32 s14, s12, s11
    s_add_u32 m0, s13, 0
    s_nop 0
    buffer_load_dwordx4 v8, s[48:51], s14 offen offset:0 lds
    buffer_load_dwordx4 v9, s[48:51], s14 offen offset:1024 lds
    buffer_load_dwordx4 v10, s[48:51], s14 offen offset:2048 lds
    buffer_load_dwordx4 v11, s[48:51], s14 offen offset:3072 lds
    s_add_u32 m0, s13, 4096
    s_nop 0
    buffer_load_dwordx4 v12, s[48:51], s14 offen offset:0 lds
    buffer_load_dwordx4 v13, s[48:51], s14 offen offset:1024 lds
    buffer_load_dwordx4 v14, s[48:51], s14 offen offset:2048 lds
    buffer_load_dwordx4 v15, s[48:51], s14 offen offset:3072 lds
    s_add_u32 s11, s11, 128
    s_cmp_eq_u32 s11, 1280
    s_cselect_b32 s11, 0, s11
    s_waitcnt vmcnt(16)
    s_barrier
    s_add_u32 s14, s12, s11
    s_add_u32 m0, s13, 32768
    s_nop 0
    buffer_load_dwordx4 v8, s[48:51], s14 offen offset:0 lds
    buffer_load_dwordx4 v9, s[48:51], s14 offen offset:1024 lds
    buffer_load_dwordx4 v10, s[48:51], s14 offen offset:2048 lds
    buffer_load_dwordx4 v11, s[48:51], s14 offen offset:3072 lds
    s_add_u32 m0, s13, 36864
    s_nop 0
    buffer_load_dwordx4 v12, s[48:51], s14 offen offset:0 lds
    buffer_load_dwordx4 v13, s[48:51], s14 offen offset:1024 lds
    buffer_load_dwordx4 v14, s[48:51], s14 offen offset:2048 lds
    buffer_load_dwordx4 v15, s[48:51], s14 offen offset:3072 lds
    s_add_u32 s11, s11, 128
    s_cmp_eq_u32 s11, 1280
    s_cselect_b32 s11, 0, s11
    s_waitcnt vmcnt(16)
    s_barrier
    s_add_u32 s14, s12, s11
    s_add_u32 m0, s13, 65536
    s_nop 0
    buffer_load_dwordx4 v8, s[48:51], s14 offen offset:0 lds
    buffer_load_dwordx4 v9, s[48:51], s14 offen offset:1024 lds
    buffer_load_dwordx4 v10, s[48:51], s14 offen offset:2048 lds
    buffer_load_dwordx4 v11, s[48:51], s14 offen offset:3072 lds
    s_add_u32 m0, s13, 69632
    s_nop 0
    buffer_load_dwordx4 v12, s[48:51], s14 offen offset:0 lds
    buffer_load_dwordx4 v13, s[48:51], s14 offen offset:1024 lds
    buffer_load_dwordx4 v14, s[48:51], s14 offen offset:2048 lds
    buffer_load_dwordx4 v15, s[48:51], s14 offen offset:3072 lds
    s_add_u32 s11, s11, 128
    s_cmp_eq_u32 s11, 1280
    s_cselect_b32 s11, 0, s11
    s_waitcnt vmcnt(16)
    s_barrier
    s_add_u32 s14, s12, s11
    s_add_u32 m0, s13, 98304
    s_nop 0
    buffer_load_dwordx4 v8, s[48:51], s14 offen offset:0 lds
    buffer_load_dwordx4 v9, s[48:51], s14 offen offset:1024 lds
    buffer_load_dwordx4 v10, s[48:51], s14 offen offset:2048 lds
    buffer_load_dwordx4 v11, s[48:51], s14 offen offset:3072 lds
    s_add_u32 m0, s13, 102400
    s_nop 0
    buffer_load_dwordx4 v12, s[48:51], s14 offen offset:0 lds
    buffer_load_dwordx4 v13, s[48:51], s14 offen offset:1024 lds
    buffer_load_dwordx4 v14, s[48:51], s14 offen offset:2048 lds
    buffer_load_dwordx4 v15, s[48:51], s14 offen offset:3072 lds
    s_add_u32 s11, s11, 128
    s_cmp_eq_u32 s11, 1280
    s_cselect_b32 s11, 0, s11
    v_lshl_add_u32 v23, s9, 6, v0
    v_lshlrev_b32 v22, 1, v23
    global_load_ushort v16, v22, s[24:25]
    global_load_ushort v17, v22, s[26:27]
    global_load_ushort v18, v22, s[36:37]
    s_waitcnt vmcnt(19)
    s_barrier
    s_add_u32 s14, s12, s11
    s_add_u32 m0, s13, 0
    s_nop 0
    buffer_load_dwordx4 v8, s[48:51], s14 offen offset:0 lds
    buffer_load_dwordx4 v9, s[48:51], s14 offen offset:1024 lds
    buffer_load_dwordx4 v10, s[48:51], s14 offen offset:2048 lds
    buffer_load_dwordx4 v11, s[48:51], s14 offen offset:3072 lds
    s_add_u32 m0, s13, 4096
    s_nop 0
    buffer_load_dwordx4 v12, s[48:51], s14 offen offset:0 lds
    buffer_load_dwordx4 v13, s[48:51], s14 offen offset:1024 lds
    buffer_load_dwordx4 v14, s[48:51], s14 offen offset:2048 lds
    buffer_load_dwordx4 v15, s[48:51], s14 offen offset:3072 lds
    s_add_u32 s11, s11, 128
    s_cmp_eq_u32 s11, 1280
    s_cselect_b32 s11, 0, s11
    s_waitcnt vmcnt(19)
    s_barrier
    s_add_u32 s14, s12, s11
    s_add_u32 m0, s13, 32768
    s_nop 0
    buffer_load_dwordx4 v8, s[48:51], s14 offen offset:0 lds
    buffer_load_dwordx4 v9, s[48:51], s14 offen offset:1024 lds
    buffer_load_dwordx4 v10, s[48:51], s14 offen offset:2048 lds
    buffer_load_dwordx4 v11, s[48:51], s14 offen offset:3072 lds
    s_add_u32 m0, s13, 36864
    s_nop 0
    buffer_load_dwordx4 v12, s[48:51], s14 offen offset:0 lds
    buffer_load_dwordx4 v13, s[48:51], s14 offen offset:1024 lds
    buffer_load_dwordx4 v14, s[48:51], s14 offen offset:2048 lds
    buffer_load_dwordx4 v15, s[48:51], s14 offen offset:3072 lds
    s_add_u32 s11, s11, 128
    s_cmp_eq_u32 s11, 1280
    s_cselect_b32 s11, 0, s11
    s_mov_b32 s52, s8
    s_mov_b32 s53, s9
    s_lshr_b32 s6, s5, 3
    s_mul_i32 s67, s6, 5
    s_lshr_b32 s67, s67, 1
    s_lshl2_add_u32 s65, s4, s6
    s_and_b32 s66, s5, 3
    s_bfe_u32 s8, s5, 0x10002
    s_mul_i32 s8, s8, 80
    s_add_u32 s9, s8, 64
    s_lshl4_add_u32 s60, s66, s8
    s_sub_u32 s61, 304, s60
    s_add_u32 s62, 320, s60
    s_sub_u32 s63, 624, s60
    s_sub_u32 s11, 304, s9
    s_bitcmp1_b32 s66, 0
    s_cselect_b32 s64, s11, s9
    s_bitcmp1_b32 s66, 1
    s_cselect_b32 s10, 320, 0
    s_add_u32 s64, s64, s10
    s_bitcmp0_b32 s3, 1
    s_cselect_b32 s72, s32, s34
    s_cselect_b32 s73, s33, s35
    s_mov_b32 s74, 819200
    s_mov_b32 s75, 0x20000
    s_and_b32 s10, s3, 3
    v_lshrrev_b32 v2, 3, v0
    v_mul_u32_u24 v2, 1280, v2
    v_lshrrev_b32 v3, 4, v0
    v_and_b32 v4, 7, v0
    v_xor_b32 v4, v4, v3
    s_and_b32 s11, s10, 1
    s_lshl_b32 s12, s11, 2
    v_xor_b32 v4, s12, v4
    v_xor_b32 v5, 4, v4
    v_lshl_add_u32 v4, v4, 4, v2
    v_lshl_add_u32 v5, v5, 4, v2
    s_cmp_eq_u32 s11, 0
    s_cselect_b32 s12, s60, s62
    s_cselect_b32 s13, 0, 8
    v_mov_b32 v6, s12
    v_add_u32 v6, s13, v6
    v_mul_u32_u24 v6, 1280, v6
    v_add_u32 v250, v6, v4
    s_cselect_b32 s12, s60, s63
    s_cselect_b32 s13, 8, 0
    v_mov_b32 v6, s12
    v_add_u32 v6, s13, v6
    v_mul_u32_u24 v6, 1280, v6
    v_add_u32 v251, v6, v5
    s_cselect_b32 s12, s61, s63
    s_cselect_b32 s13, 0, 8
    v_mov_b32 v6, s12
    v_add_u32 v6, s13, v6
    v_mul_u32_u24 v6, 1280, v6
    v_add_u32 v252, v6, v4
    s_cselect_b32 s12, s61, s64
    s_cselect_b32 s13, 8, 0
    v_mov_b32 v6, s12
    v_add_u32 v6, s13, v6
    v_mul_u32_u24 v6, 1280, v6
    v_add_u32 v253, v6, v5
    s_cselect_b32 s12, s62, s64
    s_cselect_b32 s13, 0, 8
    v_mov_b32 v6, s12
    v_add_u32 v6, s13, v6
    v_mul_u32_u24 v6, 1280, v6
    v_add_u32 v254, v6, v4
    s_mul_i32 s70, s10, 5120
    s_lshl_b32 s69, s67, 7
    s_mov_b32 s8, s52
    s_mov_b32 s9, s53
    s_and_b32 s14, s3, 1
    s_lshl1_add_u32 s14, s5, s14
    s_mul_i32 s14, s14, 20480
    v_lshlrev_b32 v2, 4, v0
    buffer_load_dwordx4 v[100:103], v2, s[72:75], s14 offen offset:0
    buffer_load_dwordx4 v[104:107], v2, s[72:75], s14 offen offset:1024
    buffer_load_dwordx4 v[108:111], v2, s[72:75], s14 offen offset:2048
    buffer_load_dwordx4 v[112:115], v2, s[72:75], s14 offen offset:3072
    s_add_u32 s14, s14, 4096
    s_waitcnt vmcnt(23)
    s_barrier
    buffer_load_dwordx4 v[116:119], v2, s[72:75], s14 offen offset:0
    buffer_load_dwordx4 v[120:123], v2, s[72:75], s14 offen offset:1024
    buffer_load_dwordx4 v[124:127], v2, s[72:75], s14 offen offset:2048
    buffer_load_dwordx4 v[128:131], v2, s[72:75], s14 offen offset:3072
    s_add_u32 s14, s14, 4096
    s_waitcnt vmcnt(16)
    s_barrier
    buffer_load_dwordx4 v[132:135], v2, s[72:75], s14 offen offset:0
    buffer_load_dwordx4 v[136:139], v2, s[72:75], s14 offen offset:1024
    buffer_load_dwordx4 v[140:143], v2, s[72:75], s14 offen offset:2048
    buffer_load_dwordx4 v[144:147], v2, s[72:75], s14 offen offset:3072
    s_add_u32 s14, s14, 4096
    v_lshlrev_b32 v18, 16, v18
    v_mul_f32 v18, 0x3fb8aa3b, v18
    v_exp_f32 v18, v18
    v_lshlrev_b32 v16, 16, v16
    v_lshlrev_b32 v17, 16, v17
    v_cvt_pk_bf16_f32 v18, v18, v18
    v_lshlrev_b32 v18, 16, v18
    v_mul_f32 v20, v18, v16
    v_mul_f32 v21, v18, v17
    v_mul_f32 v20, 0x3fb8aa3b, v20
    v_mul_f32 v21, 0x3e22f983, v21
    v_mul_f32 v22, 0x42000000, v20
    v_mul_f32 v25, 0x42000000, v21
    v_exp_f32 v22, v22
    v_fract_f32 v25, v25
    v_cos_f32 v24, v25
    v_sin_f32 v25, v25
    v_mul_f32 v24, v22, v24
    v_mul_f32 v25, v22, v25
    v_mul_f32 v22, 0x44000000, v20
    v_mul_f32 v27, 0x44000000, v21
    v_exp_f32 v22, v22
    v_fract_f32 v27, v27
    v_cos_f32 v26, v27
    v_sin_f32 v27, v27
    v_mul_f32 v26, v22, v26
    v_mul_f32 v27, v22, v27
    s_sub_u32 s10, s3, 4
    s_lshl_b32 s11, s10, 7
    v_cvt_f32_u32 v16, s11
    v_mul_f32 v22, v16, v20
    v_mul_f32 v29, v16, v21
    v_exp_f32 v22, v22
    v_fract_f32 v29, v29
    v_cos_f32 v28, v29
    v_sin_f32 v29, v29
    v_mul_f32 v28, v22, v28
    v_mul_f32 v29, v22, v29
    s_waitcnt vmcnt(12)
    s_barrier
    buffer_load_dwordx4 v[148:151], v2, s[72:75], s14 offen offset:0
    buffer_load_dwordx4 v[152:155], v2, s[72:75], s14 offen offset:1024
    buffer_load_dwordx4 v[156:159], v2, s[72:75], s14 offen offset:2048
    buffer_load_dwordx4 v[160:163], v2, s[72:75], s14 offen offset:3072
    s_add_u32 s14, s14, 4096
    v_lshlrev_b32 v48, 3, v0
    v_add_u32 v48, 159744, v48
    v_lshlrev_b32 v49, 4, v23
    s_sub_u32 s48, s8, s10
    s_sub_u32 s48, s48, 1
    s_cmp_lt_i32 s48, 0
    s_cselect_b32 s52, 0, s68
    s_mov_b32 s14, 57344
    s_cselect_b32 s14, 2130706432, s14
    s_max_i32 s48, s48, 0
    s_mul_i32 s48, s48, 10240
    s_add_u32 s48, s48, s14
    s_sub_u32 s49, s8, s10
    s_sub_u32 s49, s49, 5
    s_cmp_lt_i32 s49, 0
    s_cselect_b32 s53, 0, s68
    s_mov_b32 s14, 57344
    s_cselect_b32 s14, 2130706432, s14
    s_max_i32 s49, s49, 0
    s_mul_i32 s49, s49, 10240
    s_add_u32 s49, s49, s14
    s_sub_u32 s50, s8, s10
    s_sub_u32 s50, s50, 9
    s_cmp_lt_i32 s50, 0
    s_cselect_b32 s54, 0, s68
    s_mov_b32 s14, 57344
    s_cselect_b32 s14, 2130706432, s14
    s_max_i32 s50, s50, 0
    s_mul_i32 s50, s50, 10240
    s_add_u32 s50, s50, s14
    s_sub_u32 s51, s8, s10
    s_sub_u32 s51, s51, 13
    s_cmp_lt_i32 s51, 0
    s_cselect_b32 s55, 0, s68
    s_mov_b32 s14, 57344
    s_cselect_b32 s14, 2130706432, s14
    s_max_i32 s51, s51, 0
    s_mul_i32 s51, s51, 10240
    s_add_u32 s51, s51, s14
    s_mul_i32 s12, s8, 10240
    s_add_u32 s12, s12, 57344
    s_barrier
    s_cmp_lg_u32 s3, 4
    s_cbranch_scc1 L_Bl_nopub
    ds_read_b64 v[32:33], v48 offset:0
    ds_read_b64 v[36:37], v48 offset:512
    ds_read_b64 v[40:41], v48 offset:1024
    ds_read_b64 v[44:45], v48 offset:1536
    v_mov_b32 v46, s68
    v_mov_b32 v47, s68
    s_waitcnt lgkmcnt(0)
    v_fma_f32 v36, v24, v32, v36
    v_fma_f32 v37, v24, v33, v37
    v_fma_f32 v36, -v25, v33, v36
    v_fmac_f32 v37, v25, v32
    v_fma_f32 v40, v24, v36, v40
    v_fma_f32 v41, v24, v37, v41
    v_fma_f32 v40, -v25, v37, v40
    v_fmac_f32 v41, v25, v36
    v_fma_f32 v44, v24, v40, v44
    v_fma_f32 v45, v24, v41, v45
    v_fma_f32 v44, -v25, v41, v44
    v_fmac_f32 v45, v25, v40
    buffer_store_dwordx4 v[44:47], v49, s[56:59], s12 offen sc1
L_Bl_nopub:
    s_add_u32 m0, s70, 0
    s_nop 0
    buffer_load_dwordx4 v250, s[72:75], s69 offen lds
    s_add_u32 m0, s70, 1024
    s_nop 0
    buffer_load_dwordx4 v251, s[72:75], s69 offen lds
    s_add_u32 m0, s70, 2048
    s_nop 0
    buffer_load_dwordx4 v252, s[72:75], s69 offen lds
    s_add_u32 m0, s70, 3072
    s_nop 0
    buffer_load_dwordx4 v253, s[72:75], s69 offen lds
    s_add_u32 m0, s70, 4096
    s_nop 0
    buffer_load_dwordx4 v254, s[72:75], s69 offen lds
    s_add_u32 s69, s69, 128
    s_cmp_eq_u32 s69, 1280
    s_cselect_b32 s69, 0, s69
    s_add_u32 m0, s70, 20480
    s_nop 0
    buffer_load_dwordx4 v250, s[72:75], s69 offen lds
    s_add_u32 m0, s70, 21504
    s_nop 0
    buffer_load_dwordx4 v251, s[72:75], s69 offen lds
    s_add_u32 m0, s70, 22528
    s_nop 0
    buffer_load_dwordx4 v252, s[72:75], s69 offen lds
    s_add_u32 m0, s70, 23552
    s_nop 0
    buffer_load_dwordx4 v253, s[72:75], s69 offen lds
    s_add_u32 m0, s70, 24576
    s_nop 0
    buffer_load_dwordx4 v254, s[72:75], s69 offen lds
    s_add_u32 s69, s69, 128
    s_cmp_eq_u32 s69, 1280
    s_cselect_b32 s69, 0, s69
    s_add_u32 m0, s70, 40960
    s_nop 0
    buffer_load_dwordx4 v250, s[72:75], s69 offen lds
    s_add_u32 m0, s70, 41984
    s_nop 0
    buffer_load_dwordx4 v251, s[72:75], s69 offen lds
    s_add_u32 m0, s70, 43008
    s_nop 0
    buffer_load_dwordx4 v252, s[72:75], s69 offen lds
    s_add_u32 m0, s70, 44032
    s_nop 0
    buffer_load_dwordx4 v253, s[72:75], s69 offen lds
    s_add_u32 m0, s70, 45056
    s_nop 0
    buffer_load_dwordx4 v254, s[72:75], s69 offen lds
    s_add_u32 s69, s69, 128
    s_cmp_eq_u32 s69, 1280
    s_cselect_b32 s69, 0, s69
    s_add_u32 m0, s70, 61440
    s_nop 0
    buffer_load_dwordx4 v250, s[72:75], s69 offen lds
    s_add_u32 m0, s70, 62464
    s_nop 0
    buffer_load_dwordx4 v251, s[72:75], s69 offen lds
    s_add_u32 m0, s70, 63488
    s_nop 0
    buffer_load_dwordx4 v252, s[72:75], s69 offen lds
    s_add_u32 m0, s70, 64512
    s_nop 0
    buffer_load_dwordx4 v253, s[72:75], s69 offen lds
    s_add_u32 m0, s70, 65536
    s_nop 0
    buffer_load_dwordx4 v254, s[72:75], s69 offen lds
    s_add_u32 s69, s69, 128
    s_cmp_eq_u32 s69, 1280
    s_cselect_b32 s69, 0, s69
    s_mov_b32 s15, 0x20000
L_Bl_poll:
    buffer_load_dwordx4 v[32:35], v49, s[56:59], s48 offen sc1
    buffer_load_dwordx4 v[36:39], v49, s[56:59], s49 offen sc1
    buffer_load_dwordx4 v[40:43], v49, s[56:59], s50 offen sc1
    buffer_load_dwordx4 v[44:47], v49, s[56:59], s51 offen sc1
    s_waitcnt vmcnt(0)
    v_xor_b32 v34, s52, v34
    v_xor_b32 v38, s53, v38
    v_xor_b32 v42, s54, v42
    v_xor_b32 v46, s55, v46
    v_or3_b32 v22, v34, v38, v42
    v_or_b32 v22, v22, v46
    v_cmp_ne_u32 vcc, 0, v22
    s_cbranch_vccz L_Bl_ok
    s_sleep 2
    s_sub_u32 s15, s15, 1
    s_cbranch_scc0 L_Bl_poll
L_Bl_ok:
    v_fma_f32 v40, v26, v44, v40
    v_fma_f32 v41, v26, v45, v41
    v_fma_f32 v40, -v27, v45, v40
    v_fmac_f32 v41, v27, v44
    v_fma_f32 v36, v26, v40, v36
    v_fma_f32 v37, v26, v41, v37
    v_fma_f32 v36, -v27, v41, v36
    v_fmac_f32 v37, v27, v40
    v_fma_f32 v32, v26, v36, v32
    v_fma_f32 v33, v26, v37, v33
    v_fma_f32 v32, -v27, v37, v32
    v_fmac_f32 v33, v27, v36
    v_mul_f32 v36, v28, v32
    v_mul_f32 v37, v28, v33
    v_fma_f32 v36, -v29, v33, v36
    v_fmac_f32 v37, v29, v32
    s_lshl_b32 s11, s10, 9
    v_add_u32 v48, s11, v48
    ds_write_b64 v48, v[36:37] offset:2048
    s_waitcnt lgkmcnt(0)
    s_barrier
    s_add_u32 m0, s70, 81920
    s_nop 0
    buffer_load_dwordx4 v250, s[72:75], s69 offen lds
    s_add_u32 m0, s70, 82944
    s_nop 0
    buffer_load_dwordx4 v251, s[72:75], s69 offen lds
    s_add_u32 m0, s70, 83968
    s_nop 0
    buffer_load_dwordx4 v252, s[72:75], s69 offen lds
    s_add_u32 m0, s70, 84992
    s_nop 0
    buffer_load_dwordx4 v253, s[72:75], s69 offen lds
    s_add_u32 m0, s70, 86016
    s_nop 0
    buffer_load_dwordx4 v254, s[72:75], s69 offen lds
    s_add_u32 s69, s69, 128
    s_cmp_eq_u32 s69, 1280
    s_cselect_b32 s69, 0, s69
    s_add_u32 m0, s70, 102400
    s_nop 0
    buffer_load_dwordx4 v250, s[72:75], s69 offen lds
    s_add_u32 m0, s70, 103424
    s_nop 0
    buffer_load_dwordx4 v251, s[72:75], s69 offen lds
    s_add_u32 m0, s70, 104448
    s_nop 0
    buffer_load_dwordx4 v252, s[72:75], s69 offen lds
    s_add_u32 m0, s70, 105472
    s_nop 0
    buffer_load_dwordx4 v253, s[72:75], s69 offen lds
    s_add_u32 m0, s70, 106496
    s_nop 0
    buffer_load_dwordx4 v254, s[72:75], s69 offen lds
    s_add_u32 s69, s69, 128
    s_cmp_eq_u32 s69, 1280
    s_cselect_b32 s69, 0, s69
    s_waitcnt vmcnt(10)
    v_mov_b32 v32, 159444
    v_mov_b32 v33, 1
    s_mov_b64 exec, 1
    ds_add_u32 v32, v33
    s_mov_b64 exec, -1
    v_mov_b32 v32, 159448
    s_mov_b32 s15, 0x800000
L_lw1:
    ds_read_b32 v33, v32
    s_waitcnt lgkmcnt(0)
    v_readfirstlane_b32 s0, v33
    s_cmp_ge_u32 s0, 4
    s_cbranch_scc1 L_lw1_ok
    s_sub_u32 s15, s15, 1
    s_cbranch_scc0 L_lw1
L_lw1_ok:
    s_add_u32 m0, s70, 122880
    s_nop 0
    buffer_load_dwordx4 v250, s[72:75], s69 offen lds
    s_add_u32 m0, s70, 123904
    s_nop 0
    buffer_load_dwordx4 v251, s[72:75], s69 offen lds
    s_add_u32 m0, s70, 124928
    s_nop 0
    buffer_load_dwordx4 v252, s[72:75], s69 offen lds
    s_add_u32 m0, s70, 125952
    s_nop 0
    buffer_load_dwordx4 v253, s[72:75], s69 offen lds
    s_add_u32 m0, s70, 126976
    s_nop 0
    buffer_load_dwordx4 v254, s[72:75], s69 offen lds
    s_add_u32 s69, s69, 128
    s_cmp_eq_u32 s69, 1280
    s_cselect_b32 s69, 0, s69
    s_branch L_P3l
L_Bc:
    s_lshr_b32 s10, s3, 1
    s_and_b32 s11, s3, 1
    v_and_b32 v2, 31, v0
    v_lshrrev_b32 v3, 5, v0
    s_lshl1_add_u32 s12, s9, s11
    v_lshl_add_u32 v4, s12, 5, v2
    v_lshlrev_b32 v4, 1, v4
    s_waitcnt lgkmcnt(0)
    s_load_dword s68, s[46:47], 40960
    s_mov_b32 s56, s46
    s_mov_b32 s57, s47
    s_mov_b32 s58, 13336576
    s_mov_b32 s59, 0x20000
    global_load_ushort v8, v4, s[24:25]
    global_load_ushort v9, v4, s[26:27]
    global_load_ushort v10, v4, s[36:37]
    v_bfe_u32 v4, v2, 2, 1
    v_lshlrev_b32 v4, 5, v4
    v_lshrrev_b32 v5, 3, v2
    v_lshl_add_u32 v4, v5, 2, v4
    v_and_b32 v5, 3, v2
    v_add_u32 v4, v4, v5
    v_bfe_u32 v5, v4, 1, 3
    v_xor_b32 v5, v5, v3
    v_lshlrev_b32 v4, 7, v4
    v_lshl_add_u32 v4, v5, 4, v4
    s_lshl_b32 s13, s10, 13
    v_add_u32 v68, s13, v4
    v_bfe_u32 v5, v2, 1, 3
    v_xor_b32 v5, v5, v3
    v_lshlrev_b32 v4, 7, v2
    v_lshl_add_u32 v4, v5, 4, v4
    s_lshl_b32 s13, s11, 12
    s_add_u32 s13, s13, 16384
    v_add_u32 v76, s13, v4
    v_xor_b32 v69, 32, v68
    v_xor_b32 v70, 64, v68
    v_xor_b32 v71, 96, v68
    v_add_u32 v72, 65536, v68
    v_add_u32 v73, 65536, v69
    v_add_u32 v74, 65536, v70
    v_add_u32 v75, 65536, v71
    v_xor_b32 v77, 32, v76
    v_xor_b32 v78, 64, v76
    v_xor_b32 v79, 96, v76
    v_add_u32 v80, 65536, v76
    v_add_u32 v81, 65536, v77
    v_add_u32 v82, 65536, v78
    v_add_u32 v83, 65536, v79
    v_lshl_add_u32 v6, s10, 1, v3
    v_lshl_add_u32 v84, s11, 5, v2
    v_lshlrev_b32 v84, 3, v84
    v_add_u32 v84, 159744, v84
    v_lshl_add_u32 v85, v6, 9, v84
    s_mul_i32 s13, s3, 9216
    s_add_u32 s13, s13, 122880
    v_mul_u32_u24 v86, 144, v2
    v_lshl_add_u32 v86, v3, 6, v86
    v_add_u32 v86, s13, v86
    v_lshrrev_b32 v4, 4, v0
    v_bfe_u32 v5, v0, 2, 2
    v_lshl_add_u32 v4, v4, 3, v5
    v_mul_u32_u24 v87, 144, v4
    v_and_b32 v4, 3, v0
    v_lshl_add_u32 v87, v4, 3, v87
    v_add_u32 v87, s13, v87
    v_lshlrev_b32 v88, 4, v0
    s_lshl1_add_u32 s14, s8, s10
    s_mul_i32 s14, s14, 80
    s_add_u32 s14, s14, s12
    s_lshl_b32 s14, s14, 11
    s_add_u32 s14, s14, 8093696
    s_lshl_b32 s7, s8, 5
    s_add_u32 s7, s7, s9
    s_lshl_b32 s7, s7, 2
    v_mov_b32 v52, 159728
    v_mov_b32 v53, 0
    ds_write_b32 v52, v53
    v_mov_b32 v56, 0
    v_mov_b32 v57, 0
    v_mov_b32 v58, 0
    v_mov_b32 v59, 0
    v_mov_b32 v60, 159296
    ds_write_b128 v60, v[56:59] offset:0
    ds_write_b128 v60, v[56:59] offset:144
    ds_write_b128 v60, v[56:59] offset:288
    s_waitcnt lgkmcnt(0)
    s_add_u32 s68, s68, 1
    s_barrier
    ds_read_b128 v[92:95], v68 offset:0
    ds_read_b128 v[96:99], v68 offset:2048
    ds_read_b128 v[100:103], v76 offset:0
    ds_read_b128 v[104:107], v76 offset:8192
    s_cmp_lg_u32 s3, 0
    s_cbranch_scc1 L_xp2
    s_getreg_b32 s15, hwreg(HW_REG_XCC_ID, 0, 4)
    v_mov_b32 v52, s68
    v_mov_b32 v53, s15
    v_mov_b32 v54, 0
    s_lshl_b32 s15, s4, 5
    s_add_u32 s15, s15, s5
    s_lshl_b32 s15, s15, 3
    s_add_u32 s15, s15, 36864
    buffer_store_dwordx2 v[52:53], v54, s[56:59], s15 offen sc1
L_xp2:
    ds_read_b128 v[108:111], v69 offset:0
    ds_read_b128 v[112:115], v69 offset:2048
    ds_read_b128 v[116:119], v77 offset:0
    ds_read_b128 v[120:123], v77 offset:8192
    s_waitcnt lgkmcnt(4)
    v_mfma_f32_32x32x16_bf16 v[124:139], v[92:95], v[100:103], 0
    v_mfma_f32_32x32x16_bf16 v[140:155], v[92:95], v[104:107], 0
    v_mfma_f32_32x32x16_bf16 v[156:171], v[96:99], v[100:103], 0
    v_mfma_f32_32x32x16_bf16 v[172:187], v[96:99], v[104:107], 0
    ds_read_b128 v[92:95], v70 offset:0
    ds_read_b128 v[96:99], v70 offset:2048
    ds_read_b128 v[100:103], v78 offset:0
    ds_read_b128 v[104:107], v78 offset:8192
    s_waitcnt lgkmcnt(4)
    v_mfma_f32_32x32x16_bf16 v[124:139], v[108:111], v[116:119], v[124:139]
    v_mfma_f32_32x32x16_bf16 v[140:155], v[108:111], v[120:123], v[140:155]
    v_mfma_f32_32x32x16_bf16 v[156:171], v[112:115], v[116:119], v[156:171]
    v_mfma_f32_32x32x16_bf16 v[172:187], v[112:115], v[120:123], v[172:187]
    ds_read_b128 v[108:111], v71 offset:0
    ds_read_b128 v[112:115], v71 offset:2048
    ds_read_b128 v[116:119], v79 offset:0
    ds_read_b128 v[120:123], v79 offset:8192
    s_waitcnt lgkmcnt(4)
    v_mfma_f32_32x32x16_bf16 v[124:139], v[92:95], v[100:103], v[124:139]
    v_mfma_f32_32x32x16_bf16 v[140:155], v[92:95], v[104:107], v[140:155]
    v_mfma_f32_32x32x16_bf16 v[156:171], v[96:99], v[100:103], v[156:171]
    v_mfma_f32_32x32x16_bf16 v[172:187], v[96:99], v[104:107], v[172:187]
    s_waitcnt lgkmcnt(0)
    v_mfma_f32_32x32x16_bf16 v[124:139], v[108:111], v[116:119], v[124:139]
    v_mfma_f32_32x32x16_bf16 v[140:155], v[108:111], v[120:123], v[140:155]
    s_barrier
    ds_read_b128 v[92:95], v68 offset:32768
    ds_read_b128 v[96:99], v68 offset:34816
    ds_read_b128 v[100:103], v76 offset:32768
    ds_read_b128 v[104:107], v76 offset:40960
    v_mfma_f32_32x32x16_bf16 v[156:171], v[112:115], v[116:119], v[156:171]
    v_mfma_f32_32x32x16_bf16 v[172:187], v[112:115], v[120:123], v[172:187]
    ds_read_b128 v[108:111], v69 offset:32768
    ds_read_b128 v[112:115], v69 offset:34816
    ds_read_b128 v[116:119], v77 offset:32768
    ds_read_b128 v[120:123], v77 offset:40960
    s_waitcnt lgkmcnt(4)
    v_mfma_f32_32x32x16_bf16 v[124:139], v[92:95], v[100:103], v[124:139]
    v_mfma_f32_32x32x16_bf16 v[140:155], v[92:95], v[104:107], v[140:155]
    v_mfma_f32_32x32x16_bf16 v[156:171], v[96:99], v[100:103], v[156:171]
    v_mfma_f32_32x32x16_bf16 v[172:187], v[96:99], v[104:107], v[172:187]
    ds_read_b128 v[92:95], v70 offset:32768
    ds_read_b128 v[96:99], v70 offset:34816
    ds_read_b128 v[100:103], v78 offset:32768
    ds_read_b128 v[104:107], v78 offset:40960
    s_waitcnt lgkmcnt(4)
    v_mfma_f32_32x32x16_bf16 v[124:139], v[108:111], v[116:119], v[124:139]
    v_mfma_f32_32x32x16_bf16 v[140:155], v[108:111], v[120:123], v[140:155]
    v_mfma_f32_32x32x16_bf16 v[156:171], v[112:115], v[116:119], v[156:171]
    v_mfma_f32_32x32x16_bf16 v[172:187], v[112:115], v[120:123], v[172:187]
    ds_read_b128 v[108:111], v71 offset:32768
    ds_read_b128 v[112:115], v71 offset:34816
    ds_read_b128 v[116:119], v79 offset:32768
    ds_read_b128 v[120:123], v79 offset:40960
    s_waitcnt lgkmcnt(4)
    v_mfma_f32_32x32x16_bf16 v[124:139], v[92:95], v[100:103], v[124:139]
    v_mfma_f32_32x32x16_bf16 v[140:155], v[92:95], v[104:107], v[140:155]
    v_mfma_f32_32x32x16_bf16 v[156:171], v[96:99], v[100:103], v[156:171]
    v_mfma_f32_32x32x16_bf16 v[172:187], v[96:99], v[104:107], v[172:187]
    s_waitcnt lgkmcnt(0)
    v_mfma_f32_32x32x16_bf16 v[124:139], v[108:111], v[116:119], v[124:139]
    v_mfma_f32_32x32x16_bf16 v[140:155], v[108:111], v[120:123], v[140:155]
    s_barrier
    ds_read_b128 v[92:95], v72 offset:0
    ds_read_b128 v[96:99], v72 offset:2048
    ds_read_b128 v[100:103], v80 offset:0
    ds_read_b128 v[104:107], v80 offset:8192
    v_mfma_f32_32x32x16_bf16 v[156:171], v[112:115], v[116:119], v[156:171]
    v_mfma_f32_32x32x16_bf16 v[172:187], v[112:115], v[120:123], v[172:187]
    ds_read_b128 v[108:111], v73 offset:0
    ds_read_b128 v[112:115], v73 offset:2048
    ds_read_b128 v[116:119], v81 offset:0
    ds_read_b128 v[120:123], v81 offset:8192
    s_waitcnt lgkmcnt(4)
    v_mfma_f32_32x32x16_bf16 v[124:139], v[92:95], v[100:103], v[124:139]
    s_waitcnt vmcnt(0)
    v_lshlrev_b32 v10, 16, v10
    v_mfma_f32_32x32x16_bf16 v[140:155], v[92:95], v[104:107], v[140:155]
    v_mul_f32 v10, 0x3fb8aa3b, v10
    v_exp_f32 v10, v10
    v_mfma_f32_32x32x16_bf16 v[156:171], v[96:99], v[100:103], v[156:171]
    v_lshlrev_b32 v8, 16, v8
    v_lshlrev_b32 v9, 16, v9
    v_mfma_f32_32x32x16_bf16 v[172:187], v[96:99], v[104:107], v[172:187]
    v_cvt_pk_bf16_f32 v10, v10, v10
    v_lshlrev_b32 v10, 16, v10
    ds_read_b128 v[92:95], v74 offset:0
    ds_read_b128 v[96:99], v74 offset:2048
    ds_read_b128 v[100:103], v82 offset:0
    ds_read_b128 v[104:107], v82 offset:8192
    s_waitcnt lgkmcnt(4)
    v_mfma_f32_32x32x16_bf16 v[124:139], v[108:111], v[116:119], v[124:139]
    v_mul_f32 v12, v10, v8
    v_mul_f32 v13, v10, v9
    v_mfma_f32_32x32x16_bf16 v[140:155], v[108:111], v[120:123], v[140:155]
    v_mul_f32 v12, 0x3fb8aa3b, v12
    v_mul_f32 v13, 0x3e22f983, v13
    v_mfma_f32_32x32x16_bf16 v[156:171], v[112:115], v[116:119], v[156:171]
    v_mul_f32 v4, 0x3f800000, v12
    v_mul_f32 v36, 0x3f800000, v13
    v_mfma_f32_32x32x16_bf16 v[172:187], v[112:115], v[120:123], v[172:187]
    v_exp_f32 v4, v4
    v_fract_f32 v36, v36
    ds_read_b128 v[108:111], v75 offset:0
    ds_read_b128 v[112:115], v75 offset:2048
    ds_read_b128 v[116:119], v83 offset:0
    ds_read_b128 v[120:123], v83 offset:8192
    s_waitcnt lgkmcnt(4)
    v_mfma_f32_32x32x16_bf16 v[124:139], v[92:95], v[100:103], v[124:139]
    v_cos_f32 v20, v36
    v_sin_f32 v36, v36
    v_mfma_f32_32x32x16_bf16 v[140:155], v[92:95], v[104:107], v[140:155]
    v_mul_f32 v20, v4, v20
    v_mul_f32 v36, v4, v36
    v_mfma_f32_32x32x16_bf16 v[156:171], v[96:99], v[100:103], v[156:171]
    v_mul_f32 v4, 0x40000000, v12
    v_mul_f32 v37, 0x40000000, v13
    v_mfma_f32_32x32x16_bf16 v[172:187], v[96:99], v[104:107], v[172:187]
    v_exp_f32 v4, v4
    v_fract_f32 v37, v37
    s_waitcnt lgkmcnt(0)
    v_mfma_f32_32x32x16_bf16 v[124:139], v[108:111], v[116:119], v[124:139]
    v_cos_f32 v21, v37
    v_sin_f32 v37, v37
    v_mfma_f32_32x32x16_bf16 v[140:155], v[108:111], v[120:123], v[140:155]
    v_mul_f32 v21, v4, v21
    v_mul_f32 v37, v4, v37
    s_barrier
    ds_read_b128 v[92:95], v72 offset:32768
    ds_read_b128 v[96:99], v72 offset:34816
    ds_read_b128 v[100:103], v80 offset:32768
    ds_read_b128 v[104:107], v80 offset:40960
    v_mfma_f32_32x32x16_bf16 v[156:171], v[112:115], v[116:119], v[156:171]
    v_mul_f32 v4, 0x40400000, v12
    v_mul_f32 v38, 0x40400000, v13
    v_mfma_f32_32x32x16_bf16 v[172:187], v[112:115], v[120:123], v[172:187]
    v_exp_f32 v4, v4
    v_fract_f32 v38, v38
    ds_read_b128 v[108:111], v73 offset:32768
    ds_read_b128 v[112:115], v73 offset:34816
    ds_read_b128 v[116:119], v81 offset:32768
    ds_read_b128 v[120:123], v81 offset:40960
    s_waitcnt lgkmcnt(4)
    v_mfma_f32_32x32x16_bf16 v[124:139], v[92:95], v[100:103], v[124:139]
    v_cos_f32 v22, v38
    v_sin_f32 v38, v38
    v_mfma_f32_32x32x16_bf16 v[140:155], v[92:95], v[104:107], v[140:155]
    v_mul_f32 v22, v4, v22
    v_mul_f32 v38, v4, v38
    v_mfma_f32_32x32x16_bf16 v[156:171], v[96:99], v[100:103], v[156:171]
    v_mul_f32 v4, 0x40800000, v12
    v_mul_f32 v39, 0x40800000, v13
    v_mfma_f32_32x32x16_bf16 v[172:187], v[96:99], v[104:107], v[172:187]
    v_exp_f32 v4, v4
    v_fract_f32 v39, v39
    ds_read_b128 v[92:95], v74 offset:32768
    ds_read_b128 v[96:99], v74 offset:34816
    ds_read_b128 v[100:103], v82 offset:32768
    ds_read_b128 v[104:107], v82 offset:40960
    s_waitcnt lgkmcnt(4)
    v_mfma_f32_32x32x16_bf16 v[124:139], v[108:111], v[116:119], v[124:139]
    v_cos_f32 v23, v39
    v_sin_f32 v39, v39
    v_mfma_f32_32x32x16_bf16 v[140:155], v[108:111], v[120:123], v[140:155]
    v_mul_f32 v23, v4, v23
    v_mul_f32 v39, v4, v39
    v_mfma_f32_32x32x16_bf16 v[156:171], v[112:115], v[116:119], v[156:171]
    v_mul_f32 v4, 0x40a00000, v12
    v_mul_f32 v40, 0x40a00000, v13
    v_mfma_f32_32x32x16_bf16 v[172:187], v[112:115], v[120:123], v[172:187]
    v_exp_f32 v4, v4
    v_fract_f32 v40, v40
    ds_read_b128 v[108:111], v75 offset:32768
    ds_read_b128 v[112:115], v75 offset:34816
    ds_read_b128 v[116:119], v83 offset:32768
    ds_read_b128 v[120:123], v83 offset:40960
    s_waitcnt lgkmcnt(4)
    v_mfma_f32_32x32x16_bf16 v[124:139], v[92:95], v[100:103], v[124:139]
    v_cos_f32 v24, v40
    v_sin_f32 v40, v40
    v_mfma_f32_32x32x16_bf16 v[140:155], v[92:95], v[104:107], v[140:155]
    v_mul_f32 v24, v4, v24
    v_mul_f32 v40, v4, v40
    v_mfma_f32_32x32x16_bf16 v[156:171], v[96:99], v[100:103], v[156:171]
    v_mul_f32 v4, 0x40c00000, v12
    v_mul_f32 v41, 0x40c00000, v13
    v_mfma_f32_32x32x16_bf16 v[172:187], v[96:99], v[104:107], v[172:187]
    v_exp_f32 v4, v4
    v_fract_f32 v41, v41
    s_waitcnt lgkmcnt(0)
    v_mfma_f32_32x32x16_bf16 v[124:139], v[108:111], v[116:119], v[124:139]
    v_cos_f32 v25, v41
    v_sin_f32 v41, v41
    v_mfma_f32_32x32x16_bf16 v[140:155], v[108:111], v[120:123], v[140:155]
    v_mul_f32 v25, v4, v25
    v_mul_f32 v41, v4, v41
    s_barrier
    ds_read_b128 v[92:95], v68 offset:0
    ds_read_b128 v[96:99], v68 offset:2048
    ds_read_b128 v[100:103], v76 offset:0
    ds_read_b128 v[104:107], v76 offset:8192
    v_mfma_f32_32x32x16_bf16 v[156:171], v[112:115], v[116:119], v[156:171]
    v_mul_f32 v4, 0x40e00000, v12
    v_mul_f32 v42, 0x40e00000, v13
    v_mfma_f32_32x32x16_bf16 v[172:187], v[112:115], v[120:123], v[172:187]
    v_exp_f32 v4, v4
    v_fract_f32 v42, v42
    ds_read_b128 v[108:111], v69 offset:0
    ds_read_b128 v[112:115], v69 offset:2048
    ds_read_b128 v[116:119], v77 offset:0
    ds_read_b128 v[120:123], v77 offset:8192
    s_waitcnt lgkmcnt(4)
    v_mfma_f32_32x32x16_bf16 v[124:139], v[92:95], v[100:103], v[124:139]
    v_cos_f32 v26, v42
    v_sin_f32 v42, v42
    v_mfma_f32_32x32x16_bf16 v[140:155], v[92:95], v[104:107], v[140:155]
    v_mul_f32 v26, v4, v26
    v_mul_f32 v42, v4, v42
    v_mfma_f32_32x32x16_bf16 v[156:171], v[96:99], v[100:103], v[156:171]
    v_mul_f32 v4, 0x41000000, v12
    v_mul_f32 v43, 0x41000000, v13
    v_mfma_f32_32x32x16_bf16 v[172:187], v[96:99], v[104:107], v[172:187]
    v_exp_f32 v4, v4
    v_fract_f32 v43, v43
    ds_read_b128 v[92:95], v70 offset:0
    ds_read_b128 v[96:99], v70 offset:2048
    ds_read_b128 v[100:103], v78 offset:0
    ds_read_b128 v[104:107], v78 offset:8192
    s_waitcnt lgkmcnt(4)
    v_mfma_f32_32x32x16_bf16 v[124:139], v[108:111], v[116:119], v[124:139]
    v_cos_f32 v27, v43
    v_sin_f32 v43, v43
    v_mfma_f32_32x32x16_bf16 v[140:155], v[108:111], v[120:123], v[140:155]
    v_mul_f32 v27, v4, v27
    v_mul_f32 v43, v4, v43
    v_mfma_f32_32x32x16_bf16 v[156:171], v[112:115], v[116:119], v[156:171]
    v_mul_f32 v4, 0x41100000, v12
    v_mul_f32 v44, 0x41100000, v13
    v_mfma_f32_32x32x16_bf16 v[172:187], v[112:115], v[120:123], v[172:187]
    v_exp_f32 v4, v4
    v_fract_f32 v44, v44
    ds_read_b128 v[108:111], v71 offset:0
    ds_read_b128 v[112:115], v71 offset:2048
    ds_read_b128 v[116:119], v79 offset:0
    ds_read_b128 v[120:123], v79 offset:8192
    s_waitcnt lgkmcnt(4)
    v_mfma_f32_32x32x16_bf16 v[124:139], v[92:95], v[100:103], v[124:139]
    v_cos_f32 v28, v44
    v_sin_f32 v44, v44
    v_mfma_f32_32x32x16_bf16 v[140:155], v[92:95], v[104:107], v[140:155]
    v_mul_f32 v28, v4, v28
    v_mul_f32 v44, v4, v44
    v_mfma_f32_32x32x16_bf16 v[156:171], v[96:99], v[100:103], v[156:171]
    v_mul_f32 v4, 0x41200000, v12
    v_mul_f32 v45, 0x41200000, v13
    v_mfma_f32_32x32x16_bf16 v[172:187], v[96:99], v[104:107], v[172:187]
    v_exp_f32 v4, v4
    v_fract_f32 v45, v45
    s_waitcnt lgkmcnt(0)
    v_mfma_f32_32x32x16_bf16 v[124:139], v[108:111], v[116:119], v[124:139]
    v_cos_f32 v29, v45
    v_sin_f32 v45, v45
    v_mfma_f32_32x32x16_bf16 v[140:155], v[108:111], v[120:123], v[140:155]
    v_mul_f32 v29, v4, v29
    v_mul_f32 v45, v4, v45
    s_barrier
    ds_read_b128 v[92:95], v68 offset:32768
    ds_read_b128 v[96:99], v68 offset:34816
    ds_read_b128 v[100:103], v76 offset:32768
    ds_read_b128 v[104:107], v76 offset:40960
    v_mfma_f32_32x32x16_bf16 v[156:171], v[112:115], v[116:119], v[156:171]
    v_mul_f32 v4, 0x41300000, v12
    v_mul_f32 v46, 0x41300000, v13
    v_mfma_f32_32x32x16_bf16 v[172:187], v[112:115], v[120:123], v[172:187]
    v_exp_f32 v4, v4
    v_fract_f32 v46, v46
    ds_read_b128 v[108:111], v69 offset:32768
    ds_read_b128 v[112:115], v69 offset:34816
    ds_read_b128 v[116:119], v77 offset:32768
    ds_read_b128 v[120:123], v77 offset:40960
    s_waitcnt lgkmcnt(4)
    v_mfma_f32_32x32x16_bf16 v[124:139], v[92:95], v[100:103], v[124:139]
    v_cos_f32 v30, v46
    v_sin_f32 v46, v46
    v_mfma_f32_32x32x16_bf16 v[140:155], v[92:95], v[104:107], v[140:155]
    v_mul_f32 v30, v4, v30
    v_mul_f32 v46, v4, v46
    v_mfma_f32_32x32x16_bf16 v[156:171], v[96:99], v[100:103], v[156:171]
    v_mul_f32 v4, 0x41400000, v12
    v_mul_f32 v47, 0x41400000, v13
    v_mfma_f32_32x32x16_bf16 v[172:187], v[96:99], v[104:107], v[172:187]
    v_exp_f32 v4, v4
    v_fract_f32 v47, v47
    ds_read_b128 v[92:95], v70 offset:32768
    ds_read_b128 v[96:99], v70 offset:34816
    ds_read_b128 v[100:103], v78 offset:32768
    ds_read_b128 v[104:107], v78 offset:40960
    s_waitcnt lgkmcnt(4)
    v_mfma_f32_32x32x16_bf16 v[124:139], v[108:111], v[116:119], v[124:139]
    v_cos_f32 v31, v47
    v_sin_f32 v47, v47
    v_mfma_f32_32x32x16_bf16 v[140:155], v[108:111], v[120:123], v[140:155]
    v_mul_f32 v31, v4, v31
    v_mul_f32 v47, v4, v47
    v_mfma_f32_32x32x16_bf16 v[156:171], v[112:115], v[116:119], v[156:171]
    v_mul_f32 v4, 0x41500000, v12
    v_mul_f32 v48, 0x41500000, v13
    v_mfma_f32_32x32x16_bf16 v[172:187], v[112:115], v[120:123], v[172:187]
    v_exp_f32 v4, v4
    v_fract_f32 v48, v48
    ds_read_b128 v[108:111], v71 offset:32768
    ds_read_b128 v[112:115], v71 offset:34816
    ds_read_b128 v[116:119], v79 offset:32768
    ds_read_b128 v[120:123], v79 offset:40960
    s_waitcnt lgkmcnt(4)
    v_mfma_f32_32x32x16_bf16 v[124:139], v[92:95], v[100:103], v[124:139]
    v_cos_f32 v32, v48
    v_sin_f32 v48, v48
    v_mfma_f32_32x32x16_bf16 v[140:155], v[92:95], v[104:107], v[140:155]
    v_mul_f32 v32, v4, v32
    v_mul_f32 v48, v4, v48
    v_mfma_f32_32x32x16_bf16 v[156:171], v[96:99], v[100:103], v[156:171]
    v_mul_f32 v4, 0x41600000, v12
    v_mul_f32 v49, 0x41600000, v13
    v_mfma_f32_32x32x16_bf16 v[172:187], v[96:99], v[104:107], v[172:187]
    v_exp_f32 v4, v4
    v_fract_f32 v49, v49
    s_waitcnt lgkmcnt(0)
    v_mfma_f32_32x32x16_bf16 v[124:139], v[108:111], v[116:119], v[124:139]
    v_cos_f32 v33, v49
    v_sin_f32 v49, v49
    v_mfma_f32_32x32x16_bf16 v[140:155], v[108:111], v[120:123], v[140:155]
    v_mul_f32 v33, v4, v33
    v_mul_f32 v49, v4, v49
    s_barrier
    ds_read_b128 v[92:95], v72 offset:0
    ds_read_b128 v[96:99], v72 offset:2048
    ds_read_b128 v[100:103], v80 offset:0
    ds_read_b128 v[104:107], v80 offset:8192
    v_mfma_f32_32x32x16_bf16 v[156:171], v[112:115], v[116:119], v[156:171]
    v_mul_f32 v4, 0x41700000, v12
    v_mul_f32 v50, 0x41700000, v13
    v_mfma_f32_32x32x16_bf16 v[172:187], v[112:115], v[120:123], v[172:187]
    v_exp_f32 v4, v4
    v_fract_f32 v50, v50
    ds_read_b128 v[108:111], v73 offset:0
    ds_read_b128 v[112:115], v73 offset:2048
    ds_read_b128 v[116:119], v81 offset:0
    ds_read_b128 v[120:123], v81 offset:8192
    s_waitcnt lgkmcnt(4)
    v_mfma_f32_32x32x16_bf16 v[124:139], v[92:95], v[100:103], v[124:139]
    v_cos_f32 v34, v50
    v_sin_f32 v50, v50
    v_mfma_f32_32x32x16_bf16 v[140:155], v[92:95], v[104:107], v[140:155]
    v_mul_f32 v34, v4, v34
    v_mul_f32 v50, v4, v50
    v_mfma_f32_32x32x16_bf16 v[156:171], v[96:99], v[100:103], v[156:171]
    v_mul_f32 v4, 0x41800000, v12
    v_mul_f32 v51, 0x41800000, v13
    v_mfma_f32_32x32x16_bf16 v[172:187], v[96:99], v[104:107], v[172:187]
    v_exp_f32 v4, v4
    v_fract_f32 v51, v51
    ds_read_b128 v[92:95], v74 offset:0
    ds_read_b128 v[96:99], v74 offset:2048
    ds_read_b128 v[100:103], v82 offset:0
    ds_read_b128 v[104:107], v82 offset:8192
    s_waitcnt lgkmcnt(4)
    v_mfma_f32_32x32x16_bf16 v[124:139], v[108:111], v[116:119], v[124:139]
    v_cos_f32 v35, v51
    v_sin_f32 v51, v51
    v_mfma_f32_32x32x16_bf16 v[140:155], v[108:111], v[120:123], v[140:155]
    v_mul_f32 v35, v4, v35
    v_mul_f32 v51, v4, v51
    v_mfma_f32_32x32x16_bf16 v[156:171], v[112:115], v[116:119], v[156:171]
    v_mul_f32 v4, 0x42000000, v12
    v_mul_f32 v15, 0x42000000, v13
    v_mfma_f32_32x32x16_bf16 v[172:187], v[112:115], v[120:123], v[172:187]
    v_exp_f32 v4, v4
    v_fract_f32 v15, v15
    ds_read_b128 v[108:111], v75 offset:0
    ds_read_b128 v[112:115], v75 offset:2048
    ds_read_b128 v[116:119], v83 offset:0
    ds_read_b128 v[120:123], v83 offset:8192
    s_waitcnt lgkmcnt(4)
    v_mfma_f32_32x32x16_bf16 v[124:139], v[92:95], v[100:103], v[124:139]
    v_cos_f32 v14, v15
    v_sin_f32 v15, v15
    v_mfma_f32_32x32x16_bf16 v[140:155], v[92:95], v[104:107], v[140:155]
    v_mul_f32 v14, v4, v14
    v_mul_f32 v15, v4, v15
    v_mfma_f32_32x32x16_bf16 v[156:171], v[96:99], v[100:103], v[156:171]
    v_cvt_f32_u32 v5, v6
    v_mul_f32 v5, 0x42000000, v5
    v_mfma_f32_32x32x16_bf16 v[172:187], v[96:99], v[104:107], v[172:187]
    v_mul_f32 v4, v5, v12
    v_mul_f32 v17, v5, v13
    s_waitcnt lgkmcnt(0)
    v_mfma_f32_32x32x16_bf16 v[124:139], v[108:111], v[116:119], v[124:139]
    v_exp_f32 v4, v4
    v_fract_f32 v17, v17
    v_mfma_f32_32x32x16_bf16 v[140:155], v[108:111], v[120:123], v[140:155]
    v_cos_f32 v16, v17
    v_sin_f32 v17, v17
    s_barrier
    ds_read_b128 v[92:95], v72 offset:32768
    ds_read_b128 v[96:99], v72 offset:34816
    ds_read_b128 v[100:103], v80 offset:32768
    ds_read_b128 v[104:107], v80 offset:40960
    v_mfma_f32_32x32x16_bf16 v[156:171], v[112:115], v[116:119], v[156:171]
    v_mul_f32 v16, v4, v16
    v_mul_f32 v17, v4, v17
    v_mfma_f32_32x32x16_bf16 v[172:187], v[112:115], v[120:123], v[172:187]
    v_mul_f32 v4, v8, v8
    v_fmac_f32 v4, v9, v9
    ds_read_b128 v[108:111], v73 offset:32768
    ds_read_b128 v[112:115], v73 offset:34816
    ds_read_b128 v[116:119], v81 offset:32768
    ds_read_b128 v[120:123], v81 offset:40960
    s_waitcnt lgkmcnt(4)
    v_mfma_f32_32x32x16_bf16 v[124:139], v[92:95], v[100:103], v[124:139]
    v_rcp_f32 v4, v4
    v_add_f32 v5, -1.0, v20
    v_mfma_f32_32x32x16_bf16 v[140:155], v[92:95], v[104:107], v[140:155]
    v_mul_f32 v18, v5, v8
    v_fmac_f32 v18, v36, v9
    v_mfma_f32_32x32x16_bf16 v[156:171], v[96:99], v[100:103], v[156:171]
    v_mul_f32 v19, v36, v8
    v_fma_f32 v19, -v5, v9, v19
    v_mfma_f32_32x32x16_bf16 v[172:187], v[96:99], v[104:107], v[172:187]
    v_add_f32 v4, v4, v4
    v_mul_f32 v18, v18, v4
    ds_read_b128 v[92:95], v74 offset:32768
    ds_read_b128 v[96:99], v74 offset:34816
    ds_read_b128 v[100:103], v82 offset:32768
    ds_read_b128 v[104:107], v82 offset:40960
    s_waitcnt lgkmcnt(4)
    v_mfma_f32_32x32x16_bf16 v[124:139], v[108:111], v[116:119], v[124:139]
    v_mul_f32 v19, v19, v4
    v_mfma_f32_32x32x16_bf16 v[140:155], v[108:111], v[120:123], v[140:155]
    v_mfma_f32_32x32x16_bf16 v[156:171], v[112:115], v[116:119], v[156:171]
    v_mfma_f32_32x32x16_bf16 v[172:187], v[112:115], v[120:123], v[172:187]
    ds_read_b128 v[108:111], v75 offset:32768
    ds_read_b128 v[112:115], v75 offset:34816
    ds_read_b128 v[116:119], v83 offset:32768
    ds_read_b128 v[120:123], v83 offset:40960
    s_waitcnt lgkmcnt(4)
    v_mfma_f32_32x32x16_bf16 v[124:139], v[92:95], v[100:103], v[124:139]
    v_mfma_f32_32x32x16_bf16 v[140:155], v[92:95], v[104:107], v[140:155]
    v_mfma_f32_32x32x16_bf16 v[156:171], v[96:99], v[100:103], v[156:171]
    v_mfma_f32_32x32x16_bf16 v[172:187], v[96:99], v[104:107], v[172:187]
    s_waitcnt lgkmcnt(0)
    v_mfma_f32_32x32x16_bf16 v[124:139], v[108:111], v[116:119], v[124:139]
    v_mfma_f32_32x32x16_bf16 v[140:155], v[108:111], v[120:123], v[140:155]
    s_barrier
    ds_read_b128 v[92:95], v68 offset:0
    ds_read_b128 v[96:99], v68 offset:2048
    ds_read_b128 v[100:103], v76 offset:0
    ds_read_b128 v[104:107], v76 offset:8192
    v_mfma_f32_32x32x16_bf16 v[156:171], v[112:115], v[116:119], v[156:171]
    v_mfma_f32_32x32x16_bf16 v[172:187], v[112:115], v[120:123], v[172:187]
    ds_read_b128 v[108:111], v69 offset:0
    ds_read_b128 v[112:115], v69 offset:2048
    ds_read_b128 v[116:119], v77 offset:0
    ds_read_b128 v[120:123], v77 offset:8192
    s_waitcnt lgkmcnt(4)
    v_mfma_f32_32x32x16_bf16 v[124:139], v[92:95], v[100:103], v[124:139]
    v_mfma_f32_32x32x16_bf16 v[140:155], v[92:95], v[104:107], v[140:155]
    v_mfma_f32_32x32x16_bf16 v[156:171], v[96:99], v[100:103], v[156:171]
    v_mfma_f32_32x32x16_bf16 v[172:187], v[96:99], v[104:107], v[172:187]
    ds_read_b128 v[92:95], v70 offset:0
    ds_read_b128 v[96:99], v70 offset:2048
    ds_read_b128 v[100:103], v78 offset:0
    ds_read_b128 v[104:107], v78 offset:8192
    s_waitcnt lgkmcnt(4)
    v_mfma_f32_32x32x16_bf16 v[124:139], v[108:111], v[116:119], v[124:139]
    v_mfma_f32_32x32x16_bf16 v[140:155], v[108:111], v[120:123], v[140:155]
    v_mfma_f32_32x32x16_bf16 v[156:171], v[112:115], v[116:119], v[156:171]
    v_mfma_f32_32x32x16_bf16 v[172:187], v[112:115], v[120:123], v[172:187]
    ds_read_b128 v[108:111], v71 offset:0
    ds_read_b128 v[112:115], v71 offset:2048
    ds_read_b128 v[116:119], v79 offset:0
    ds_read_b128 v[120:123], v79 offset:8192
    s_waitcnt lgkmcnt(4)
    v_mfma_f32_32x32x16_bf16 v[124:139], v[92:95], v[100:103], v[124:139]
    v_mfma_f32_32x32x16_bf16 v[140:155], v[92:95], v[104:107], v[140:155]
    v_mfma_f32_32x32x16_bf16 v[156:171], v[96:99], v[100:103], v[156:171]
    v_mfma_f32_32x32x16_bf16 v[172:187], v[96:99], v[104:107], v[172:187]
    s_waitcnt lgkmcnt(0)
    v_mfma_f32_32x32x16_bf16 v[124:139], v[108:111], v[116:119], v[124:139]
    v_mfma_f32_32x32x16_bf16 v[140:155], v[108:111], v[120:123], v[140:155]
    s_barrier
    ds_read_b128 v[92:95], v68 offset:32768
    ds_read_b128 v[96:99], v68 offset:34816
    ds_read_b128 v[100:103], v76 offset:32768
    ds_read_b128 v[104:107], v76 offset:40960
    v_mfma_f32_32x32x16_bf16 v[156:171], v[112:115], v[116:119], v[156:171]
    v_mfma_f32_32x32x16_bf16 v[172:187], v[112:115], v[120:123], v[172:187]
    ds_read_b128 v[108:111], v69 offset:32768
    ds_read_b128 v[112:115], v69 offset:34816
    ds_read_b128 v[116:119], v77 offset:32768
    ds_read_b128 v[120:123], v77 offset:40960
    s_waitcnt lgkmcnt(4)
    v_mfma_f32_32x32x16_bf16 v[124:139], v[92:95], v[100:103], v[124:139]
    v_mfma_f32_32x32x16_bf16 v[140:155], v[92:95], v[104:107], v[140:155]
    v_mfma_f32_32x32x16_bf16 v[156:171], v[96:99], v[100:103], v[156:171]
    v_mfma_f32_32x32x16_bf16 v[172:187], v[96:99], v[104:107], v[172:187]
    ds_read_b128 v[92:95], v70 offset:32768
    ds_read_b128 v[96:99], v70 offset:34816
    ds_read_b128 v[100:103], v78 offset:32768
    ds_read_b128 v[104:107], v78 offset:40960
    s_waitcnt lgkmcnt(4)
    v_mfma_f32_32x32x16_bf16 v[124:139], v[108:111], v[116:119], v[124:139]
    v_mfma_f32_32x32x16_bf16 v[140:155], v[108:111], v[120:123], v[140:155]
    v_mfma_f32_32x32x16_bf16 v[156:171], v[112:115], v[116:119], v[156:171]
    v_mfma_f32_32x32x16_bf16 v[172:187], v[112:115], v[120:123], v[172:187]
    ds_read_b128 v[108:111], v71 offset:32768
    ds_read_b128 v[112:115], v71 offset:34816
    ds_read_b128 v[116:119], v79 offset:32768
    ds_read_b128 v[120:123], v79 offset:40960
    s_waitcnt lgkmcnt(4)
    v_mfma_f32_32x32x16_bf16 v[124:139], v[92:95], v[100:103], v[124:139]
    v_mfma_f32_32x32x16_bf16 v[140:155], v[92:95], v[104:107], v[140:155]
    v_mfma_f32_32x32x16_bf16 v[156:171], v[96:99], v[100:103], v[156:171]
    v_mfma_f32_32x32x16_bf16 v[172:187], v[96:99], v[104:107], v[172:187]
    s_waitcnt lgkmcnt(0)
    v_mfma_f32_32x32x16_bf16 v[124:139], v[108:111], v[116:119], v[124:139]
    v_mfma_f32_32x32x16_bf16 v[140:155], v[108:111], v[120:123], v[140:155]
    v_mfma_f32_32x32x16_bf16 v[156:171], v[112:115], v[116:119], v[156:171]
    v_mfma_f32_32x32x16_bf16 v[172:187], v[112:115], v[120:123], v[172:187]
    s_nop 8
    v_fmac_f32 v125, v20, v124
    v_fmac_f32 v141, v20, v140
    v_fmac_f32 v157, v20, v156
    v_fmac_f32 v173, v20, v172
    v_fma_f32 v125, -v36, v140, v125
    v_fmac_f32 v141, v36, v124
    v_fma_f32 v157, -v36, v172, v157
    v_fmac_f32 v173, v36, v156
    v_fmac_f32 v126, v20, v125
    v_fmac_f32 v142, v20, v141
    v_fmac_f32 v158, v20, v157
    v_fmac_f32 v174, v20, v173
    v_fma_f32 v126, -v36, v141, v126
    v_fmac_f32 v142, v36, v125
    v_fma_f32 v158, -v36, v173, v158
    v_fmac_f32 v174, v36, v157
    v_fmac_f32 v127, v20, v126
    v_fmac_f32 v143, v20, v142
    v_fmac_f32 v159, v20, v158
    v_fmac_f32 v175, v20, v174
    v_fma_f32 v127, -v36, v142, v127
    v_fmac_f32 v143, v36, v126
    v_fma_f32 v159, -v36, v174, v159
    v_fmac_f32 v175, v36, v158
    v_fmac_f32 v128, v20, v127
    v_fmac_f32 v144, v20, v143
    v_fmac_f32 v160, v20, v159
    v_fmac_f32 v176, v20, v175
    v_fma_f32 v128, -v36, v143, v128
    v_fmac_f32 v144, v36, v127
    v_fma_f32 v160, -v36, v175, v160
    v_fmac_f32 v176, v36, v159
    v_fmac_f32 v129, v20, v128
    v_fmac_f32 v145, v20, v144
    v_fmac_f32 v161, v20, v160
    v_fmac_f32 v177, v20, v176
    v_fma_f32 v129, -v36, v144, v129
    v_fmac_f32 v145, v36, v128
    v_fma_f32 v161, -v36, v176, v161
    v_fmac_f32 v177, v36, v160
    v_fmac_f32 v130, v20, v129
    v_fmac_f32 v146, v20, v145
    v_fmac_f32 v162, v20, v161
    v_fmac_f32 v178, v20, v177
    v_fma_f32 v130, -v36, v145, v130
    v_fmac_f32 v146, v36, v129
    v_fma_f32 v162, -v36, v177, v162
    v_fmac_f32 v178, v36, v161
    v_fmac_f32 v131, v20, v130
    v_fmac_f32 v147, v20, v146
    v_fmac_f32 v163, v20, v162
    v_fmac_f32 v179, v20, v178
    v_fma_f32 v131, -v36, v146, v131
    v_fmac_f32 v147, v36, v130
    v_fma_f32 v163, -v36, v178, v163
    v_fmac_f32 v179, v36, v162
    v_fmac_f32 v132, v20, v131
    v_fmac_f32 v148, v20, v147
    v_fmac_f32 v164, v20, v163
    v_fmac_f32 v180, v20, v179
    v_fma_f32 v132, -v36, v147, v132
    v_fmac_f32 v148, v36, v131
    v_fma_f32 v164, -v36, v179, v164
    v_fmac_f32 v180, v36, v163
    v_fmac_f32 v133, v20, v132
    v_fmac_f32 v149, v20, v148
    v_fmac_f32 v165, v20, v164
    v_fmac_f32 v181, v20, v180
    v_fma_f32 v133, -v36, v148, v133
    v_fmac_f32 v149, v36, v132
    v_fma_f32 v165, -v36, v180, v165
    v_fmac_f32 v181, v36, v164
    v_fmac_f32 v134, v20, v133
    v_fmac_f32 v150, v20, v149
    v_fmac_f32 v166, v20, v165
    v_fmac_f32 v182, v20, v181
    v_fma_f32 v134, -v36, v149, v134
    v_fmac_f32 v150, v36, v133
    v_fma_f32 v166, -v36, v181, v166
    v_fmac_f32 v182, v36, v165
    v_fmac_f32 v135, v20, v134
    v_fmac_f32 v151, v20, v150
    v_fmac_f32 v167, v20, v166
    v_fmac_f32 v183, v20, v182
    v_fma_f32 v135, -v36, v150, v135
    v_fmac_f32 v151, v36, v134
    v_fma_f32 v167, -v36, v182, v167
    v_fmac_f32 v183, v36, v166
    v_fmac_f32 v136, v20, v135
    v_fmac_f32 v152, v20, v151
    v_fmac_f32 v168, v20, v167
    v_fmac_f32 v184, v20, v183
    v_fma_f32 v136, -v36, v151, v136
    v_fmac_f32 v152, v36, v135
    v_fma_f32 v168, -v36, v183, v168
    v_fmac_f32 v184, v36, v167
    v_fmac_f32 v137, v20, v136
    v_fmac_f32 v153, v20, v152
    v_fmac_f32 v169, v20, v168
    v_fmac_f32 v185, v20, v184
    v_fma_f32 v137, -v36, v152, v137
    v_fmac_f32 v153, v36, v136
    v_fma_f32 v169, -v36, v184, v169
    v_fmac_f32 v185, v36, v168
    v_fmac_f32 v138, v20, v137
    v_fmac_f32 v154, v20, v153
    v_fmac_f32 v170, v20, v169
    v_fmac_f32 v186, v20, v185
    v_fma_f32 v138, -v36, v153, v138
    v_fmac_f32 v154, v36, v137
    v_fma_f32 v170, -v36, v185, v170
    v_fmac_f32 v186, v36, v169
    v_fmac_f32 v139, v20, v138
    v_fmac_f32 v155, v20, v154
    v_fmac_f32 v171, v20, v170
    v_fmac_f32 v187, v20, v186
    v_fma_f32 v139, -v36, v154, v139
    v_fmac_f32 v155, v36, v138
    v_fma_f32 v171, -v36, v186, v171
    v_fmac_f32 v187, v36, v170
    v_fma_f32 v92, v35, v139, v171
    v_fma_f32 v93, v35, v155, v187
    v_fma_f32 v92, -v51, v155, v92
    v_fmac_f32 v93, v51, v139
    ds_write_b64 v85, v[92:93]
    v_mov_b32 v94, v139
    v_mov_b32 v95, v155
    v_mov_b32 v96, v35
    v_mov_b32 v97, v51
    s_waitcnt lgkmcnt(0)
    s_barrier
    ds_read_b64 v[98:99], v84 offset:0
    ds_read_b64 v[100:101], v84 offset:512
    ds_read_b64 v[102:103], v84 offset:1024
    v_lshlrev_b32 v4, 3, v2
    s_lshl_b32 s13, s4, 8
    s_add_u32 s13, s13, 36864
    buffer_load_dwordx2 v[104:105], v4, s[56:59], s13 offen sc1
    v_pk_mul_f32 v[106:107], v[124:125], v[18:19] op_sel:[0,1] neg_lo:[1,0] neg_hi:[1,0]
    v_pk_mul_f32 v[124:125], v[124:125], v[18:19] op_sel_hi:[1,0]
    v_pk_fma_f32 v[124:125], v[140:141], v[18:19], v[124:125] op_sel:[0,1,0] neg_lo:[1,0,0] neg_hi:[1,0,0]
    v_pk_fma_f32 v[140:141], v[140:141], v[18:19], v[106:107] op_sel_hi:[1,0,1] neg_lo:[1,0,0] neg_hi:[1,0,0]
    v_pk_mul_f32 v[106:107], v[126:127], v[18:19] op_sel:[0,1] neg_lo:[1,0] neg_hi:[1,0]
    v_pk_mul_f32 v[126:127], v[126:127], v[18:19] op_sel_hi:[1,0]
    v_pk_fma_f32 v[126:127], v[142:143], v[18:19], v[126:127] op_sel:[0,1,0] neg_lo:[1,0,0] neg_hi:[1,0,0]
    v_pk_fma_f32 v[142:143], v[142:143], v[18:19], v[106:107] op_sel_hi:[1,0,1] neg_lo:[1,0,0] neg_hi:[1,0,0]
    v_pk_mul_f32 v[106:107], v[128:129], v[18:19] op_sel:[0,1] neg_lo:[1,0] neg_hi:[1,0]
    v_pk_mul_f32 v[128:129], v[128:129], v[18:19] op_sel_hi:[1,0]
    v_pk_fma_f32 v[128:129], v[144:145], v[18:19], v[128:129] op_sel:[0,1,0] neg_lo:[1,0,0] neg_hi:[1,0,0]
    v_pk_fma_f32 v[144:145], v[144:145], v[18:19], v[106:107] op_sel_hi:[1,0,1] neg_lo:[1,0,0] neg_hi:[1,0,0]
    v_pk_mul_f32 v[106:107], v[130:131], v[18:19] op_sel:[0,1] neg_lo:[1,0] neg_hi:[1,0]
    v_pk_mul_f32 v[130:131], v[130:131], v[18:19] op_sel_hi:[1,0]
    v_pk_fma_f32 v[130:131], v[146:147], v[18:19], v[130:131] op_sel:[0,1,0] neg_lo:[1,0,0] neg_hi:[1,0,0]
    v_pk_fma_f32 v[146:147], v[146:147], v[18:19], v[106:107] op_sel_hi:[1,0,1] neg_lo:[1,0,0] neg_hi:[1,0,0]
    v_pk_mul_f32 v[106:107], v[132:133], v[18:19] op_sel:[0,1] neg_lo:[1,0] neg_hi:[1,0]
    v_pk_mul_f32 v[132:133], v[132:133], v[18:19] op_sel_hi:[1,0]
    v_pk_fma_f32 v[132:133], v[148:149], v[18:19], v[132:133] op_sel:[0,1,0] neg_lo:[1,0,0] neg_hi:[1,0,0]
    v_pk_fma_f32 v[148:149], v[148:149], v[18:19], v[106:107] op_sel_hi:[1,0,1] neg_lo:[1,0,0] neg_hi:[1,0,0]
    v_pk_mul_f32 v[106:107], v[134:135], v[18:19] op_sel:[0,1] neg_lo:[1,0] neg_hi:[1,0]
    v_pk_mul_f32 v[134:135], v[134:135], v[18:19] op_sel_hi:[1,0]
    v_pk_fma_f32 v[134:135], v[150:151], v[18:19], v[134:135] op_sel:[0,1,0] neg_lo:[1,0,0] neg_hi:[1,0,0]
    v_pk_fma_f32 v[150:151], v[150:151], v[18:19], v[106:107] op_sel_hi:[1,0,1] neg_lo:[1,0,0] neg_hi:[1,0,0]
    v_pk_mul_f32 v[106:107], v[136:137], v[18:19] op_sel:[0,1] neg_lo:[1,0] neg_hi:[1,0]
    v_pk_mul_f32 v[136:137], v[136:137], v[18:19] op_sel_hi:[1,0]
    v_pk_fma_f32 v[136:137], v[152:153], v[18:19], v[136:137] op_sel:[0,1,0] neg_lo:[1,0,0] neg_hi:[1,0,0]
    v_pk_fma_f32 v[152:153], v[152:153], v[18:19], v[106:107] op_sel_hi:[1,0,1] neg_lo:[1,0,0] neg_hi:[1,0,0]
    v_pk_mul_f32 v[106:107], v[138:139], v[18:19] op_sel:[0,1] neg_lo:[1,0] neg_hi:[1,0]
    v_pk_mul_f32 v[138:139], v[138:139], v[18:19] op_sel_hi:[1,0]
    v_pk_fma_f32 v[138:139], v[154:155], v[18:19], v[138:139] op_sel:[0,1,0] neg_lo:[1,0,0] neg_hi:[1,0,0]
    v_pk_fma_f32 v[154:155], v[154:155], v[18:19], v[106:107] op_sel_hi:[1,0,1] neg_lo:[1,0,0] neg_hi:[1,0,0]
    v_pk_mul_f32 v[106:107], v[156:157], v[18:19] op_sel:[0,1] neg_lo:[1,0] neg_hi:[1,0]
    v_pk_mul_f32 v[156:157], v[156:157], v[18:19] op_sel_hi:[1,0]
    v_pk_fma_f32 v[156:157], v[172:173], v[18:19], v[156:157] op_sel:[0,1,0] neg_lo:[1,0,0] neg_hi:[1,0,0]
    v_pk_fma_f32 v[172:173], v[172:173], v[18:19], v[106:107] op_sel_hi:[1,0,1] neg_lo:[1,0,0] neg_hi:[1,0,0]
    v_pk_mul_f32 v[106:107], v[158:159], v[18:19] op_sel:[0,1] neg_lo:[1,0] neg_hi:[1,0]
    v_pk_mul_f32 v[158:159], v[158:159], v[18:19] op_sel_hi:[1,0]
    v_pk_fma_f32 v[158:159], v[174:175], v[18:19], v[158:159] op_sel:[0,1,0] neg_lo:[1,0,0] neg_hi:[1,0,0]
    v_pk_fma_f32 v[174:175], v[174:175], v[18:19], v[106:107] op_sel_hi:[1,0,1] neg_lo:[1,0,0] neg_hi:[1,0,0]
    v_pk_mul_f32 v[106:107], v[160:161], v[18:19] op_sel:[0,1] neg_lo:[1,0] neg_hi:[1,0]
    v_pk_mul_f32 v[160:161], v[160:161], v[18:19] op_sel_hi:[1,0]
    v_pk_fma_f32 v[160:161], v[176:177], v[18:19], v[160:161] op_sel:[0,1,0] neg_lo:[1,0,0] neg_hi:[1,0,0]
    v_pk_fma_f32 v[176:177], v[176:177], v[18:19], v[106:107] op_sel_hi:[1,0,1] neg_lo:[1,0,0] neg_hi:[1,0,0]
    v_pk_mul_f32 v[106:107], v[162:163], v[18:19] op_sel:[0,1] neg_lo:[1,0] neg_hi:[1,0]
    v_pk_mul_f32 v[162:163], v[162:163], v[18:19] op_sel_hi:[1,0]
    v_pk_fma_f32 v[162:163], v[178:179], v[18:19], v[162:163] op_sel:[0,1,0] neg_lo:[1,0,0] neg_hi:[1,0,0]
    v_pk_fma_f32 v[178:179], v[178:179], v[18:19], v[106:107] op_sel_hi:[1,0,1] neg_lo:[1,0,0] neg_hi:[1,0,0]
    v_pk_mul_f32 v[106:107], v[164:165], v[18:19] op_sel:[0,1] neg_lo:[1,0] neg_hi:[1,0]
    v_pk_mul_f32 v[164:165], v[164:165], v[18:19] op_sel_hi:[1,0]
    v_pk_fma_f32 v[164:165], v[180:181], v[18:19], v[164:165] op_sel:[0,1,0] neg_lo:[1,0,0] neg_hi:[1,0,0]
    v_pk_fma_f32 v[180:181], v[180:181], v[18:19], v[106:107] op_sel_hi:[1,0,1] neg_lo:[1,0,0] neg_hi:[1,0,0]
    v_pk_mul_f32 v[106:107], v[166:167], v[18:19] op_sel:[0,1] neg_lo:[1,0] neg_hi:[1,0]
    v_pk_mul_f32 v[166:167], v[166:167], v[18:19] op_sel_hi:[1,0]
    v_pk_fma_f32 v[166:167], v[182:183], v[18:19], v[166:167] op_sel:[0,1,0] neg_lo:[1,0,0] neg_hi:[1,0,0]
    v_pk_fma_f32 v[182:183], v[182:183], v[18:19], v[106:107] op_sel_hi:[1,0,1] neg_lo:[1,0,0] neg_hi:[1,0,0]
    v_pk_mul_f32 v[106:107], v[168:169], v[18:19] op_sel:[0,1] neg_lo:[1,0] neg_hi:[1,0]
    v_pk_mul_f32 v[168:169], v[168:169], v[18:19] op_sel_hi:[1,0]
    v_pk_fma_f32 v[168:169], v[184:185], v[18:19], v[168:169] op_sel:[0,1,0] neg_lo:[1,0,0] neg_hi:[1,0,0]
    v_pk_fma_f32 v[184:185], v[184:185], v[18:19], v[106:107] op_sel_hi:[1,0,1] neg_lo:[1,0,0] neg_hi:[1,0,0]
    v_pk_mul_f32 v[106:107], v[170:171], v[18:19] op_sel:[0,1] neg_lo:[1,0] neg_hi:[1,0]
    v_pk_mul_f32 v[170:171], v[170:171], v[18:19] op_sel_hi:[1,0]
    v_pk_fma_f32 v[170:171], v[186:187], v[18:19], v[170:171] op_sel:[0,1,0] neg_lo:[1,0,0] neg_hi:[1,0,0]
    v_pk_fma_f32 v[186:187], v[186:187], v[18:19], v[106:107] op_sel_hi:[1,0,1] neg_lo:[1,0,0] neg_hi:[1,0,0]
    s_waitcnt lgkmcnt(0)
    v_fma_f32 v100, v14, v98, v100
    v_fma_f32 v101, v14, v99, v101
    v_fma_f32 v100, -v15, v99, v100
    v_fmac_f32 v101, v15, v98
    v_fma_f32 v102, v14, v100, v102
    v_fma_f32 v103, v14, v101, v103
    v_fma_f32 v102, -v15, v101, v102
    v_fmac_f32 v103, v15, v100
    v_cmp_eq_u32 vcc, 1, v6
    s_nop 1
    v_cndmask_b32 v108, 0, v98, vcc
    v_cndmask_b32 v109, 0, v99, vcc
    v_cmp_eq_u32 vcc, 2, v6
    s_nop 1
    v_cndmask_b32 v108, v108, v100, vcc
    v_cndmask_b32 v109, v109, v101, vcc
    v_cmp_eq_u32 vcc, 3, v6
    s_nop 1
    v_cndmask_b32 v108, v108, v102, vcc
    v_cndmask_b32 v109, v109, v103, vcc
    s_getreg_b32 s13, hwreg(HW_REG_XCC_ID, 0, 4)
    s_waitcnt vmcnt(0)
    v_xor_b32 v104, s68, v104
    v_xor_b32 v105, s13, v105
    v_or_b32 v104, v104, v105
    v_cmp_ne_u32 s[50:51], 0, v104
    s_mov_b64 s[50:51], -1
    s_barrier
    ds_read_b64 v[110:111], v84 offset:2048
    ds_read_b64 v[112:113], v84 offset:2560
    ds_read_b64 v[114:115], v84 offset:3072
    ds_read_b64 v[116:117], v84 offset:3584
    s_waitcnt lgkmcnt(0)
    v_pk_add_f32 v[110:111], v[110:111], v[112:113]
    v_pk_add_f32 v[114:115], v[114:115], v[116:117]
    v_pk_add_f32 v[110:111], v[110:111], v[114:115]
    v_fma_f32 v108, v16, v110, v108
    v_fma_f32 v109, v16, v111, v109
    v_fma_f32 v108, -v17, v111, v108
    v_fmac_f32 v109, v17, v110
    v_fma_f32 v94, v96, v108, v94
    v_fma_f32 v95, v96, v109, v95
    v_fma_f32 v94, -v97, v109, v94
    v_fmac_f32 v95, v97, v108
    v_mul_f32 v112, v18, v108
    v_mul_f32 v113, v18, v109
    v_fma_f32 v112, -v19, v109, v112
    v_fmac_f32 v113, v19, v108
    v_mul_f32 v114, v18, v94
    v_mul_f32 v115, v18, v95
    v_fma_f32 v114, -v19, v95, v114
    v_fmac_f32 v115, v19, v94
    v_pk_fma_f32 v[124:125], v[20:21], v[112:113], v[124:125] op_sel_hi:[1,0,1]
    v_pk_fma_f32 v[140:141], v[20:21], v[112:113], v[140:141] op_sel:[0,1,0] neg_lo:[1,0,0] neg_hi:[1,0,0]
    v_pk_fma_f32 v[124:125], v[36:37], v[112:113], v[124:125] op_sel:[0,1,0] neg_lo:[1,0,0] neg_hi:[1,0,0]
    v_pk_fma_f32 v[140:141], v[36:37], v[112:113], v[140:141] op_sel_hi:[1,0,1] neg_lo:[1,0,0] neg_hi:[1,0,0]
    v_cvt_pk_bf16_f32 v52, v124, v125
    v_cvt_pk_bf16_f32 v56, v140, v141
    v_pk_fma_f32 v[126:127], v[22:23], v[112:113], v[126:127] op_sel_hi:[1,0,1]
    v_pk_fma_f32 v[142:143], v[22:23], v[112:113], v[142:143] op_sel:[0,1,0] neg_lo:[1,0,0] neg_hi:[1,0,0]
    v_pk_fma_f32 v[126:127], v[38:39], v[112:113], v[126:127] op_sel:[0,1,0] neg_lo:[1,0,0] neg_hi:[1,0,0]
    v_pk_fma_f32 v[142:143], v[38:39], v[112:113], v[142:143] op_sel_hi:[1,0,1] neg_lo:[1,0,0] neg_hi:[1,0,0]
    v_cvt_pk_bf16_f32 v53, v126, v127
    v_cvt_pk_bf16_f32 v57, v142, v143
    v_pk_fma_f32 v[128:129], v[24:25], v[112:113], v[128:129] op_sel_hi:[1,0,1]
    v_pk_fma_f32 v[144:145], v[24:25], v[112:113], v[144:145] op_sel:[0,1,0] neg_lo:[1,0,0] neg_hi:[1,0,0]
    v_pk_fma_f32 v[128:129], v[40:41], v[112:113], v[128:129] op_sel:[0,1,0] neg_lo:[1,0,0] neg_hi:[1,0,0]
    v_pk_fma_f32 v[144:145], v[40:41], v[112:113], v[144:145] op_sel_hi:[1,0,1] neg_lo:[1,0,0] neg_hi:[1,0,0]
    v_cvt_pk_bf16_f32 v54, v128, v129
    v_cvt_pk_bf16_f32 v58, v144, v145
    v_pk_fma_f32 v[130:131], v[26:27], v[112:113], v[130:131] op_sel_hi:[1,0,1]
    v_pk_fma_f32 v[146:147], v[26:27], v[112:113], v[146:147] op_sel:[0,1,0] neg_lo:[1,0,0] neg_hi:[1,0,0]
    v_pk_fma_f32 v[130:131], v[42:43], v[112:113], v[130:131] op_sel:[0,1,0] neg_lo:[1,0,0] neg_hi:[1,0,0]
    v_pk_fma_f32 v[146:147], v[42:43], v[112:113], v[146:147] op_sel_hi:[1,0,1] neg_lo:[1,0,0] neg_hi:[1,0,0]
    v_cvt_pk_bf16_f32 v55, v130, v131
    v_cvt_pk_bf16_f32 v59, v146, v147
    ds_write_b128 v86, v[52:55] offset:0
    ds_write_b128 v86, v[56:59] offset:4608
    v_pk_fma_f32 v[132:133], v[28:29], v[112:113], v[132:133] op_sel_hi:[1,0,1]
    v_pk_fma_f32 v[148:149], v[28:29], v[112:113], v[148:149] op_sel:[0,1,0] neg_lo:[1,0,0] neg_hi:[1,0,0]
    v_pk_fma_f32 v[132:133], v[44:45], v[112:113], v[132:133] op_sel:[0,1,0] neg_lo:[1,0,0] neg_hi:[1,0,0]
    v_pk_fma_f32 v[148:149], v[44:45], v[112:113], v[148:149] op_sel_hi:[1,0,1] neg_lo:[1,0,0] neg_hi:[1,0,0]
    v_cvt_pk_bf16_f32 v60, v132, v133
    v_cvt_pk_bf16_f32 v64, v148, v149
    v_pk_fma_f32 v[134:135], v[30:31], v[112:113], v[134:135] op_sel_hi:[1,0,1]
    v_pk_fma_f32 v[150:151], v[30:31], v[112:113], v[150:151] op_sel:[0,1,0] neg_lo:[1,0,0] neg_hi:[1,0,0]
    v_pk_fma_f32 v[134:135], v[46:47], v[112:113], v[134:135] op_sel:[0,1,0] neg_lo:[1,0,0] neg_hi:[1,0,0]
    v_pk_fma_f32 v[150:151], v[46:47], v[112:113], v[150:151] op_sel_hi:[1,0,1] neg_lo:[1,0,0] neg_hi:[1,0,0]
    v_cvt_pk_bf16_f32 v61, v134, v135
    v_cvt_pk_bf16_f32 v65, v150, v151
    v_pk_fma_f32 v[136:137], v[32:33], v[112:113], v[136:137] op_sel_hi:[1,0,1]
    v_pk_fma_f32 v[152:153], v[32:33], v[112:113], v[152:153] op_sel:[0,1,0] neg_lo:[1,0,0] neg_hi:[1,0,0]
    v_pk_fma_f32 v[136:137], v[48:49], v[112:113], v[136:137] op_sel:[0,1,0] neg_lo:[1,0,0] neg_hi:[1,0,0]
    v_pk_fma_f32 v[152:153], v[48:49], v[112:113], v[152:153] op_sel_hi:[1,0,1] neg_lo:[1,0,0] neg_hi:[1,0,0]
    v_cvt_pk_bf16_f32 v62, v136, v137
    v_cvt_pk_bf16_f32 v66, v152, v153
    v_pk_fma_f32 v[138:139], v[34:35], v[112:113], v[138:139] op_sel_hi:[1,0,1]
    v_pk_fma_f32 v[154:155], v[34:35], v[112:113], v[154:155] op_sel:[0,1,0] neg_lo:[1,0,0] neg_hi:[1,0,0]
    v_pk_fma_f32 v[138:139], v[50:51], v[112:113], v[138:139] op_sel:[0,1,0] neg_lo:[1,0,0] neg_hi:[1,0,0]
    v_pk_fma_f32 v[154:155], v[50:51], v[112:113], v[154:155] op_sel_hi:[1,0,1] neg_lo:[1,0,0] neg_hi:[1,0,0]
    v_cvt_pk_bf16_f32 v63, v138, v139
    v_cvt_pk_bf16_f32 v67, v154, v155
    ds_write_b128 v86, v[60:63] offset:16
    ds_write_b128 v86, v[64:67] offset:4624
    v_pk_fma_f32 v[156:157], v[20:21], v[114:115], v[156:157] op_sel_hi:[1,0,1]
    v_pk_fma_f32 v[172:173], v[20:21], v[114:115], v[172:173] op_sel:[0,1,0] neg_lo:[1,0,0] neg_hi:[1,0,0]
    v_pk_fma_f32 v[156:157], v[36:37], v[114:115], v[156:157] op_sel:[0,1,0] neg_lo:[1,0,0] neg_hi:[1,0,0]
    v_pk_fma_f32 v[172:173], v[36:37], v[114:115], v[172:173] op_sel_hi:[1,0,1] neg_lo:[1,0,0] neg_hi:[1,0,0]
    v_cvt_pk_bf16_f32 v52, v156, v157
    v_cvt_pk_bf16_f32 v56, v172, v173
    v_pk_fma_f32 v[158:159], v[22:23], v[114:115], v[158:159] op_sel_hi:[1,0,1]
    v_pk_fma_f32 v[174:175], v[22:23], v[114:115], v[174:175] op_sel:[0,1,0] neg_lo:[1,0,0] neg_hi:[1,0,0]
    v_pk_fma_f32 v[158:159], v[38:39], v[114:115], v[158:159] op_sel:[0,1,0] neg_lo:[1,0,0] neg_hi:[1,0,0]
    v_pk_fma_f32 v[174:175], v[38:39], v[114:115], v[174:175] op_sel_hi:[1,0,1] neg_lo:[1,0,0] neg_hi:[1,0,0]
    v_cvt_pk_bf16_f32 v53, v158, v159
    v_cvt_pk_bf16_f32 v57, v174, v175
    v_pk_fma_f32 v[160:161], v[24:25], v[114:115], v[160:161] op_sel_hi:[1,0,1]
    v_pk_fma_f32 v[176:177], v[24:25], v[114:115], v[176:177] op_sel:[0,1,0] neg_lo:[1,0,0] neg_hi:[1,0,0]
    v_pk_fma_f32 v[160:161], v[40:41], v[114:115], v[160:161] op_sel:[0,1,0] neg_lo:[1,0,0] neg_hi:[1,0,0]
    v_pk_fma_f32 v[176:177], v[40:41], v[114:115], v[176:177] op_sel_hi:[1,0,1] neg_lo:[1,0,0] neg_hi:[1,0,0]
    v_cvt_pk_bf16_f32 v54, v160, v161
    v_cvt_pk_bf16_f32 v58, v176, v177
    v_pk_fma_f32 v[162:163], v[26:27], v[114:115], v[162:163] op_sel_hi:[1,0,1]
    v_pk_fma_f32 v[178:179], v[26:27], v[114:115], v[178:179] op_sel:[0,1,0] neg_lo:[1,0,0] neg_hi:[1,0,0]
    v_pk_fma_f32 v[162:163], v[42:43], v[114:115], v[162:163] op_sel:[0,1,0] neg_lo:[1,0,0] neg_hi:[1,0,0]
    v_pk_fma_f32 v[178:179], v[42:43], v[114:115], v[178:179] op_sel_hi:[1,0,1] neg_lo:[1,0,0] neg_hi:[1,0,0]
    v_cvt_pk_bf16_f32 v55, v162, v163
    v_cvt_pk_bf16_f32 v59, v178, v179
    ds_write_b128 v86, v[52:55] offset:32
    ds_write_b128 v86, v[56:59] offset:4640
    v_pk_fma_f32 v[164:165], v[28:29], v[114:115], v[164:165] op_sel_hi:[1,0,1]
    v_pk_fma_f32 v[180:181], v[28:29], v[114:115], v[180:181] op_sel:[0,1,0] neg_lo:[1,0,0] neg_hi:[1,0,0]
    v_pk_fma_f32 v[164:165], v[44:45], v[114:115], v[164:165] op_sel:[0,1,0] neg_lo:[1,0,0] neg_hi:[1,0,0]
    v_pk_fma_f32 v[180:181], v[44:45], v[114:115], v[180:181] op_sel_hi:[1,0,1] neg_lo:[1,0,0] neg_hi:[1,0,0]
    v_cvt_pk_bf16_f32 v60, v164, v165
    v_cvt_pk_bf16_f32 v64, v180, v181
    v_pk_fma_f32 v[166:167], v[30:31], v[114:115], v[166:167] op_sel_hi:[1,0,1]
    v_pk_fma_f32 v[182:183], v[30:31], v[114:115], v[182:183] op_sel:[0,1,0] neg_lo:[1,0,0] neg_hi:[1,0,0]
    v_pk_fma_f32 v[166:167], v[46:47], v[114:115], v[166:167] op_sel:[0,1,0] neg_lo:[1,0,0] neg_hi:[1,0,0]
    v_pk_fma_f32 v[182:183], v[46:47], v[114:115], v[182:183] op_sel_hi:[1,0,1] neg_lo:[1,0,0] neg_hi:[1,0,0]
    v_cvt_pk_bf16_f32 v61, v166, v167
    v_cvt_pk_bf16_f32 v65, v182, v183
    v_pk_fma_f32 v[168:169], v[32:33], v[114:115], v[168:169] op_sel_hi:[1,0,1]
    v_pk_fma_f32 v[184:185], v[32:33], v[114:115], v[184:185] op_sel:[0,1,0] neg_lo:[1,0,0] neg_hi:[1,0,0]
    v_pk_fma_f32 v[168:169], v[48:49], v[114:115], v[168:169] op_sel:[0,1,0] neg_lo:[1,0,0] neg_hi:[1,0,0]
    v_pk_fma_f32 v[184:185], v[48:49], v[114:115], v[184:185] op_sel_hi:[1,0,1] neg_lo:[1,0,0] neg_hi:[1,0,0]
    v_cvt_pk_bf16_f32 v62, v168, v169
    v_cvt_pk_bf16_f32 v66, v184, v185
    v_pk_fma_f32 v[170:171], v[34:35], v[114:115], v[170:171] op_sel_hi:[1,0,1]
    v_pk_fma_f32 v[186:187], v[34:35], v[114:115], v[186:187] op_sel:[0,1,0] neg_lo:[1,0,0] neg_hi:[1,0,0]
    v_pk_fma_f32 v[170:171], v[50:51], v[114:115], v[170:171] op_sel:[0,1,0] neg_lo:[1,0,0] neg_hi:[1,0,0]
    v_pk_fma_f32 v[186:187], v[50:51], v[114:115], v[186:187] op_sel_hi:[1,0,1] neg_lo:[1,0,0] neg_hi:[1,0,0]
    v_cvt_pk_bf16_f32 v63, v170, v171
    v_cvt_pk_bf16_f32 v67, v186, v187
    ds_write_b128 v86, v[60:63] offset:48
    ds_write_b128 v86, v[64:67] offset:4656
    s_waitcnt lgkmcnt(0)
    ds_read_b64_tr_b16 v[124:125], v87 offset:0
    ds_read_b64_tr_b16 v[126:127], v87 offset:576
    ds_read_b64_tr_b16 v[128:129], v87 offset:4608
    ds_read_b64_tr_b16 v[130:131], v87 offset:5184
    ds_read_b64_tr_b16 v[132:133], v87 offset:32
    ds_read_b64_tr_b16 v[134:135], v87 offset:608
    ds_read_b64_tr_b16 v[136:137], v87 offset:4640
    ds_read_b64_tr_b16 v[138:139], v87 offset:5216
    ds_read_b64_tr_b16 v[140:141], v87 offset:64
    ds_read_b64_tr_b16 v[142:143], v87 offset:640
    ds_read_b64_tr_b16 v[144:145], v87 offset:4672
    ds_read_b64_tr_b16 v[146:147], v87 offset:5248
    ds_read_b64_tr_b16 v[148:149], v87 offset:96
    ds_read_b64_tr_b16 v[150:151], v87 offset:672
    ds_read_b64_tr_b16 v[152:153], v87 offset:4704
    ds_read_b64_tr_b16 v[154:155], v87 offset:5280
    s_cmp_eq_u64 s[50:51], 0
    s_cbranch_scc1 L_Bc_local
    s_waitcnt lgkmcnt(14)
    buffer_store_dwordx4 v[124:127], v88, s[56:59], s14 offen offset:0 sc1
    s_waitcnt lgkmcnt(12)
    buffer_store_dwordx4 v[128:131], v88, s[56:59], s14 offen offset:1024 sc1
    s_add_u32 s14, s14, 40960
    s_waitcnt lgkmcnt(10)
    buffer_store_dwordx4 v[132:135], v88, s[56:59], s14 offen offset:0 sc1
    s_waitcnt lgkmcnt(8)
    buffer_store_dwordx4 v[136:139], v88, s[56:59], s14 offen offset:1024 sc1
    s_add_u32 s14, s14, 40960
    s_waitcnt lgkmcnt(6)
    buffer_store_dwordx4 v[140:143], v88, s[56:59], s14 offen offset:0 sc1
    s_waitcnt lgkmcnt(4)
    buffer_store_dwordx4 v[144:147], v88, s[56:59], s14 offen offset:1024 sc1
    s_add_u32 s14, s14, 40960
    s_waitcnt lgkmcnt(2)
    buffer_store_dwordx4 v[148:151], v88, s[56:59], s14 offen offset:0 sc1
    s_waitcnt lgkmcnt(0)
    buffer_store_dwordx4 v[152:155], v88, s[56:59], s14 offen offset:1024 sc1
    s_branch L_Bc_st
L_Bc_local:
    s_waitcnt lgkmcnt(14)
    buffer_store_dwordx4 v[124:127], v88, s[56:59], s14 offen offset:0
    s_waitcnt lgkmcnt(12)
    buffer_store_dwordx4 v[128:131], v88, s[56:59], s14 offen offset:1024
    s_add_u32 s14, s14, 40960
    s_waitcnt lgkmcnt(10)
    buffer_store_dwordx4 v[132:135], v88, s[56:59], s14 offen offset:0
    s_waitcnt lgkmcnt(8)
    buffer_store_dwordx4 v[136:139], v88, s[56:59], s14 offen offset:1024
    s_add_u32 s14, s14, 40960
    s_waitcnt lgkmcnt(6)
    buffer_store_dwordx4 v[140:143], v88, s[56:59], s14 offen offset:0
    s_waitcnt lgkmcnt(4)
    buffer_store_dwordx4 v[144:147], v88, s[56:59], s14 offen offset:1024
    s_add_u32 s14, s14, 40960
    s_waitcnt lgkmcnt(2)
    buffer_store_dwordx4 v[148:151], v88, s[56:59], s14 offen offset:0
    s_waitcnt lgkmcnt(0)
    buffer_store_dwordx4 v[152:155], v88, s[56:59], s14 offen offset:1024
L_Bc_st:
    s_add_u32 s52, s7, 32768
    s_lshr_b32 s6, s5, 3
    s_mul_i32 s67, s6, 5
    s_lshr_b32 s67, s67, 1
    s_lshl2_add_u32 s65, s4, s6
    s_and_b32 s66, s5, 3
    s_bfe_u32 s8, s5, 0x10002
    s_mul_i32 s8, s8, 80
    s_add_u32 s9, s8, 64
    s_lshl4_add_u32 s60, s66, s8
    s_sub_u32 s61, 304, s60
    s_add_u32 s62, 320, s60
    s_sub_u32 s63, 624, s60
    s_sub_u32 s11, 304, s9
    s_bitcmp1_b32 s66, 0
    s_cselect_b32 s64, s11, s9
    s_bitcmp1_b32 s66, 1
    s_cselect_b32 s10, 320, 0
    s_add_u32 s64, s64, s10
    s_bitcmp0_b32 s3, 1
    s_cselect_b32 s72, s32, s34
    s_cselect_b32 s73, s33, s35
    s_mov_b32 s74, 819200
    s_mov_b32 s75, 0x20000
    s_mov_b32 s71, 1
    s_branch L_P3c
L_A:
    s_sub_u32 s6, s5, 20
    s_and_b32 s7, s6, 1
    s_lshr_b32 s6, s6, 1
    s_lshl2_add_u32 s6, s4, s6
    s_lshr_b32 s8, s6, 1
    s_and_b32 s9, s6, 1
    s_cmp_ge_u32 s3, 4
    s_cbranch_scc0 L_Ac
    s_sub_u32 s10, s3, 4
    s_lshl2_add_u32 s11, s8, s10
    s_lshl1_add_u32 s11, s11, s9
    s_lshl_b32 s52, s11, 6
    s_mul_i32 s11, s11, 20480
    v_lshrrev_b32 v2, 2, v0
    v_and_b32 v3, 3, v0
    v_mul_u32_u24 v4, 1280, v2
    v_lshlrev_b32 v6, 4, v3
    v_sub_u32 v5, v4, v6
    v_add_u32 v4, v4, v6
    v_add_u32 v5, 368, v5
    s_waitcnt lgkmcnt(0)
    s_mov_b32 s48, s16
    s_mov_b32 s49, s17
    s_mov_b32 s50, 2621440
    s_mov_b32 s51, 0x20000
    buffer_load_dwordx4 v[8:11], v4, s[48:51], s11 offen offset:0
    buffer_load_dwordx4 v[16:19], v4, s[48:51], s11 offen offset:640
    buffer_load_dwordx4 v[12:15], v5, s[48:51], s11 offen offset:256
    buffer_load_dwordx4 v[20:23], v5, s[48:51], s11 offen offset:896
    buffer_load_dwordx4 v[24:27], v4, s[48:51], s11 offen offset:64
    buffer_load_dwordx4 v[32:35], v4, s[48:51], s11 offen offset:704
    buffer_load_dwordx4 v[28:31], v5, s[48:51], s11 offen offset:192
    buffer_load_dwordx4 v[36:39], v5, s[48:51], s11 offen offset:832
    buffer_load_dwordx4 v[40:43], v4, s[48:51], s11 offen offset:128
    buffer_load_dwordx4 v[48:51], v4, s[48:51], s11 offen offset:768
    buffer_load_dwordx4 v[44:47], v5, s[48:51], s11 offen offset:128
    buffer_load_dwordx4 v[52:55], v5, s[48:51], s11 offen offset:768
    buffer_load_dwordx4 v[56:59], v4, s[48:51], s11 offen offset:192
    buffer_load_dwordx4 v[64:67], v4, s[48:51], s11 offen offset:832
    buffer_load_dwordx4 v[60:63], v5, s[48:51], s11 offen offset:64
    buffer_load_dwordx4 v[68:71], v5, s[48:51], s11 offen offset:704
    buffer_load_dwordx4 v[72:75], v4, s[48:51], s11 offen offset:256
    buffer_load_dwordx4 v[80:83], v4, s[48:51], s11 offen offset:896
    buffer_load_dwordx4 v[76:79], v5, s[48:51], s11 offen offset:0
    buffer_load_dwordx4 v[84:87], v5, s[48:51], s11 offen offset:640
    s_waitcnt lgkmcnt(0)
    s_load_dword s68, s[46:47], 40960
    s_mov_b32 s56, s46
    s_mov_b32 s57, s47
    s_mov_b32 s58, 13336576
    s_mov_b32 s59, 0x20000
    v_lshlrev_b32 v4, 4, v3
    v_sub_u32 v5, 368, v4
    s_mov_b32 s48, s40
    s_mov_b32 s49, s41
    s_mov_b32 s50, 1280
    s_mov_b32 s51, 0x20000
    s_lshl_b32 s12, s10, 10
    s_add_u32 m0, s12, 65536
    v_lshlrev_b32 v6, 4, v0
    buffer_load_dwordx4 v6, s[48:51], s12 offen lds
    v_add_u32 v4, 65536, v4
    v_add_u32 v5, 65536, v5
    v_lshlrev_b32 v6, 1, v3
    v_xor_b32 v6, v6, v2
    v_lshlrev_b32 v6, 4, v6
    v_lshl_add_u32 v6, v3, 8, v6
    s_mul_i32 s12, s10, 5120
    s_add_u32 s12, s12, 122880
    v_add_u32 v6, s12, v6
    s_cmp_eq_u32 s7, 0
    s_cselect_b32 s12, 1.0, -1.0
    s_mov_b32 s13, s12
    s_mov_b32 s14, 0xffff0000
    s_waitcnt vmcnt(17)
    v_lshlrev_b32 v168, 16, v8
    v_and_b32 v169, s14, v8
    v_and_b32 v176, s14, v15
    v_lshlrev_b32 v177, 16, v15
    v_lshlrev_b32 v184, 16, v16
    v_and_b32 v185, s14, v16
    v_and_b32 v192, s14, v23
    v_lshlrev_b32 v193, 16, v23
    v_lshlrev_b32 v170, 16, v9
    v_and_b32 v171, s14, v9
    v_and_b32 v178, s14, v14
    v_lshlrev_b32 v179, 16, v14
    v_lshlrev_b32 v186, 16, v17
    v_and_b32 v187, s14, v17
    v_and_b32 v194, s14, v22
    v_lshlrev_b32 v195, 16, v22
    v_lshlrev_b32 v172, 16, v10
    v_and_b32 v173, s14, v10
    v_and_b32 v180, s14, v13
    v_lshlrev_b32 v181, 16, v13
    v_lshlrev_b32 v188, 16, v18
    v_and_b32 v189, s14, v18
    v_and_b32 v196, s14, v21
    v_lshlrev_b32 v197, 16, v21
    v_lshlrev_b32 v174, 16, v11
    v_and_b32 v175, s14, v11
    v_and_b32 v182, s14, v12
    v_lshlrev_b32 v183, 16, v12
    v_lshlrev_b32 v190, 16, v19
    v_and_b32 v191, s14, v19
    v_and_b32 v198, s14, v20
    v_lshlrev_b32 v199, 16, v20
    v_pk_fma_f32 v[168:169], v[168:169], s[12:13], v[184:185]
    v_pk_fma_f32 v[176:177], v[192:193], s[12:13], v[176:177]
    v_pk_fma_f32 v[170:171], v[170:171], s[12:13], v[186:187]
    v_pk_fma_f32 v[178:179], v[194:195], s[12:13], v[178:179]
    v_pk_fma_f32 v[172:173], v[172:173], s[12:13], v[188:189]
    v_pk_fma_f32 v[180:181], v[196:197], s[12:13], v[180:181]
    v_pk_fma_f32 v[174:175], v[174:175], s[12:13], v[190:191]
    v_pk_fma_f32 v[182:183], v[198:199], s[12:13], v[182:183]
    v_pk_add_f32 v[184:185], v[168:169], v[176:177]
    v_pk_add_f32 v[192:193], v[168:169], v[176:177] neg_lo:[0,1] neg_hi:[0,1]
    v_pk_add_f32 v[186:187], v[170:171], v[178:179]
    v_pk_add_f32 v[194:195], v[170:171], v[178:179] neg_lo:[0,1] neg_hi:[0,1]
    v_pk_add_f32 v[188:189], v[172:173], v[180:181]
    v_pk_add_f32 v[196:197], v[172:173], v[180:181] neg_lo:[0,1] neg_hi:[0,1]
    v_pk_add_f32 v[190:191], v[174:175], v[182:183]
    v_pk_add_f32 v[198:199], v[174:175], v[182:183] neg_lo:[0,1] neg_hi:[0,1]
    v_cvt_pk_bf16_f32 v200, v184, v185
    v_cvt_pk_bf16_f32 v204, v192, v193
    v_cvt_pk_bf16_f32 v201, v186, v187
    v_cvt_pk_bf16_f32 v205, v194, v195
    v_cvt_pk_bf16_f32 v202, v188, v189
    v_cvt_pk_bf16_f32 v206, v196, v197
    v_cvt_pk_bf16_f32 v203, v190, v191
    v_cvt_pk_bf16_f32 v207, v198, v199
    ds_write_b128 v6, v[200:203] offset:0
    ds_write_b128 v6, v[204:207] offset:20480
    s_waitcnt vmcnt(13)
    v_lshlrev_b32 v168, 16, v24
    v_and_b32 v169, s14, v24
    v_and_b32 v176, s14, v31
    v_lshlrev_b32 v177, 16, v31
    v_lshlrev_b32 v184, 16, v32
    v_and_b32 v185, s14, v32
    v_and_b32 v192, s14, v39
    v_lshlrev_b32 v193, 16, v39
    v_lshlrev_b32 v170, 16, v25
    v_and_b32 v171, s14, v25
    v_and_b32 v178, s14, v30
    v_lshlrev_b32 v179, 16, v30
    v_lshlrev_b32 v186, 16, v33
    v_and_b32 v187, s14, v33
    v_and_b32 v194, s14, v38
    v_lshlrev_b32 v195, 16, v38
    v_lshlrev_b32 v172, 16, v26
    v_and_b32 v173, s14, v26
    v_and_b32 v180, s14, v29
    v_lshlrev_b32 v181, 16, v29
    v_lshlrev_b32 v188, 16, v34
    v_and_b32 v189, s14, v34
    v_and_b32 v196, s14, v37
    v_lshlrev_b32 v197, 16, v37
    v_lshlrev_b32 v174, 16, v27
    v_and_b32 v175, s14, v27
    v_and_b32 v182, s14, v28
    v_lshlrev_b32 v183, 16, v28
    v_lshlrev_b32 v190, 16, v35
    v_and_b32 v191, s14, v35
    v_and_b32 v198, s14, v36
    v_lshlrev_b32 v199, 16, v36
    v_pk_fma_f32 v[168:169], v[168:169], s[12:13], v[184:185]
    v_pk_fma_f32 v[176:177], v[192:193], s[12:13], v[176:177]
    v_pk_fma_f32 v[170:171], v[170:171], s[12:13], v[186:187]
    v_pk_fma_f32 v[178:179], v[194:195], s[12:13], v[178:179]
    v_pk_fma_f32 v[172:173], v[172:173], s[12:13], v[188:189]
    v_pk_fma_f32 v[180:181], v[196:197], s[12:13], v[180:181]
    v_pk_fma_f32 v[174:175], v[174:175], s[12:13], v[190:191]
    v_pk_fma_f32 v[182:183], v[198:199], s[12:13], v[182:183]
    v_pk_add_f32 v[184:185], v[168:169], v[176:177]
    v_pk_add_f32 v[192:193], v[168:169], v[176:177] neg_lo:[0,1] neg_hi:[0,1]
    v_pk_add_f32 v[186:187], v[170:171], v[178:179]
    v_pk_add_f32 v[194:195], v[170:171], v[178:179] neg_lo:[0,1] neg_hi:[0,1]
    v_pk_add_f32 v[188:189], v[172:173], v[180:181]
    v_pk_add_f32 v[196:197], v[172:173], v[180:181] neg_lo:[0,1] neg_hi:[0,1]
    v_pk_add_f32 v[190:191], v[174:175], v[182:183]
    v_pk_add_f32 v[198:199], v[174:175], v[182:183] neg_lo:[0,1] neg_hi:[0,1]
    v_cvt_pk_bf16_f32 v200, v184, v185
    v_cvt_pk_bf16_f32 v204, v192, v193
    v_cvt_pk_bf16_f32 v201, v186, v187
    v_cvt_pk_bf16_f32 v205, v194, v195
    v_cvt_pk_bf16_f32 v202, v188, v189
    v_cvt_pk_bf16_f32 v206, v196, v197
    v_cvt_pk_bf16_f32 v203, v190, v191
    v_cvt_pk_bf16_f32 v207, v198, v199
    ds_write_b128 v6, v[200:203] offset:1024
    ds_write_b128 v6, v[204:207] offset:21504
    s_waitcnt vmcnt(9)
    v_lshlrev_b32 v168, 16, v40
    v_and_b32 v169, s14, v40
    v_and_b32 v176, s14, v47
    v_lshlrev_b32 v177, 16, v47
    v_lshlrev_b32 v184, 16, v48
    v_and_b32 v185, s14, v48
    v_and_b32 v192, s14, v55
    v_lshlrev_b32 v193, 16, v55
    v_lshlrev_b32 v170, 16, v41
    v_and_b32 v171, s14, v41
    v_and_b32 v178, s14, v46
    v_lshlrev_b32 v179, 16, v46
    v_lshlrev_b32 v186, 16, v49
    v_and_b32 v187, s14, v49
    v_and_b32 v194, s14, v54
    v_lshlrev_b32 v195, 16, v54
    v_lshlrev_b32 v172, 16, v42
    v_and_b32 v173, s14, v42
    v_and_b32 v180, s14, v45
    v_lshlrev_b32 v181, 16, v45
    v_lshlrev_b32 v188, 16, v50
    v_and_b32 v189, s14, v50
    v_and_b32 v196, s14, v53
    v_lshlrev_b32 v197, 16, v53
    v_lshlrev_b32 v174, 16, v43
    v_and_b32 v175, s14, v43
    v_and_b32 v182, s14, v44
    v_lshlrev_b32 v183, 16, v44
    v_lshlrev_b32 v190, 16, v51
    v_and_b32 v191, s14, v51
    v_and_b32 v198, s14, v52
    v_lshlrev_b32 v199, 16, v52
    v_pk_fma_f32 v[168:169], v[168:169], s[12:13], v[184:185]
    v_pk_fma_f32 v[176:177], v[192:193], s[12:13], v[176:177]
    v_pk_fma_f32 v[170:171], v[170:171], s[12:13], v[186:187]
    v_pk_fma_f32 v[178:179], v[194:195], s[12:13], v[178:179]
    v_pk_fma_f32 v[172:173], v[172:173], s[12:13], v[188:189]
    v_pk_fma_f32 v[180:181], v[196:197], s[12:13], v[180:181]
    v_pk_fma_f32 v[174:175], v[174:175], s[12:13], v[190:191]
    v_pk_fma_f32 v[182:183], v[198:199], s[12:13], v[182:183]
    v_pk_add_f32 v[184:185], v[168:169], v[176:177]
    v_pk_add_f32 v[192:193], v[168:169], v[176:177] neg_lo:[0,1] neg_hi:[0,1]
    v_pk_add_f32 v[186:187], v[170:171], v[178:179]
    v_pk_add_f32 v[194:195], v[170:171], v[178:179] neg_lo:[0,1] neg_hi:[0,1]
    v_pk_add_f32 v[188:189], v[172:173], v[180:181]
    v_pk_add_f32 v[196:197], v[172:173], v[180:181] neg_lo:[0,1] neg_hi:[0,1]
    v_pk_add_f32 v[190:191], v[174:175], v[182:183]
    v_pk_add_f32 v[198:199], v[174:175], v[182:183] neg_lo:[0,1] neg_hi:[0,1]
    v_cvt_pk_bf16_f32 v200, v184, v185
    v_cvt_pk_bf16_f32 v204, v192, v193
    v_cvt_pk_bf16_f32 v201, v186, v187
    v_cvt_pk_bf16_f32 v205, v194, v195
    v_cvt_pk_bf16_f32 v202, v188, v189
    v_cvt_pk_bf16_f32 v206, v196, v197
    v_cvt_pk_bf16_f32 v203, v190, v191
    v_cvt_pk_bf16_f32 v207, v198, v199
    ds_write_b128 v6, v[200:203] offset:2048
    ds_write_b128 v6, v[204:207] offset:22528
    s_waitcnt vmcnt(5)
    v_lshlrev_b32 v168, 16, v56
    v_and_b32 v169, s14, v56
    v_and_b32 v176, s14, v63
    v_lshlrev_b32 v177, 16, v63
    v_lshlrev_b32 v184, 16, v64
    v_and_b32 v185, s14, v64
    v_and_b32 v192, s14, v71
    v_lshlrev_b32 v193, 16, v71
    v_lshlrev_b32 v170, 16, v57
    v_and_b32 v171, s14, v57
    v_and_b32 v178, s14, v62
    v_lshlrev_b32 v179, 16, v62
    v_lshlrev_b32 v186, 16, v65
    v_and_b32 v187, s14, v65
    v_and_b32 v194, s14, v70
    v_lshlrev_b32 v195, 16, v70
    v_lshlrev_b32 v172, 16, v58
    v_and_b32 v173, s14, v58
    v_and_b32 v180, s14, v61
    v_lshlrev_b32 v181, 16, v61
    v_lshlrev_b32 v188, 16, v66
    v_and_b32 v189, s14, v66
    v_and_b32 v196, s14, v69
    v_lshlrev_b32 v197, 16, v69
    v_lshlrev_b32 v174, 16, v59
    v_and_b32 v175, s14, v59
    v_and_b32 v182, s14, v60
    v_lshlrev_b32 v183, 16, v60
    v_lshlrev_b32 v190, 16, v67
    v_and_b32 v191, s14, v67
    v_and_b32 v198, s14, v68
    v_lshlrev_b32 v199, 16, v68
    v_pk_fma_f32 v[168:169], v[168:169], s[12:13], v[184:185]
    v_pk_fma_f32 v[176:177], v[192:193], s[12:13], v[176:177]
    v_pk_fma_f32 v[170:171], v[170:171], s[12:13], v[186:187]
    v_pk_fma_f32 v[178:179], v[194:195], s[12:13], v[178:179]
    v_pk_fma_f32 v[172:173], v[172:173], s[12:13], v[188:189]
    v_pk_fma_f32 v[180:181], v[196:197], s[12:13], v[180:181]
    v_pk_fma_f32 v[174:175], v[174:175], s[12:13], v[190:191]
    v_pk_fma_f32 v[182:183], v[198:199], s[12:13], v[182:183]
    v_pk_add_f32 v[184:185], v[168:169], v[176:177]
    v_pk_add_f32 v[192:193], v[168:169], v[176:177] neg_lo:[0,1] neg_hi:[0,1]
    v_pk_add_f32 v[186:187], v[170:171], v[178:179]
    v_pk_add_f32 v[194:195], v[170:171], v[178:179] neg_lo:[0,1] neg_hi:[0,1]
    v_pk_add_f32 v[188:189], v[172:173], v[180:181]
    v_pk_add_f32 v[196:197], v[172:173], v[180:181] neg_lo:[0,1] neg_hi:[0,1]
    v_pk_add_f32 v[190:191], v[174:175], v[182:183]
    v_pk_add_f32 v[198:199], v[174:175], v[182:183] neg_lo:[0,1] neg_hi:[0,1]
    v_cvt_pk_bf16_f32 v200, v184, v185
    v_cvt_pk_bf16_f32 v204, v192, v193
    v_cvt_pk_bf16_f32 v201, v186, v187
    v_cvt_pk_bf16_f32 v205, v194, v195
    v_cvt_pk_bf16_f32 v202, v188, v189
    v_cvt_pk_bf16_f32 v206, v196, v197
    v_cvt_pk_bf16_f32 v203, v190, v191
    v_cvt_pk_bf16_f32 v207, v198, v199
    ds_write_b128 v6, v[200:203] offset:3072
    ds_write_b128 v6, v[204:207] offset:23552
    s_waitcnt vmcnt(0)
    v_lshlrev_b32 v168, 16, v72
    v_and_b32 v169, s14, v72
    v_and_b32 v176, s14, v79
    v_lshlrev_b32 v177, 16, v79
    v_lshlrev_b32 v184, 16, v80
    v_and_b32 v185, s14, v80
    v_and_b32 v192, s14, v87
    v_lshlrev_b32 v193, 16, v87
    v_lshlrev_b32 v170, 16, v73
    v_and_b32 v171, s14, v73
    v_and_b32 v178, s14, v78
    v_lshlrev_b32 v179, 16, v78
    v_lshlrev_b32 v186, 16, v81
    v_and_b32 v187, s14, v81
    v_and_b32 v194, s14, v86
    v_lshlrev_b32 v195, 16, v86
    v_lshlrev_b32 v172, 16, v74
    v_and_b32 v173, s14, v74
    v_and_b32 v180, s14, v77
    v_lshlrev_b32 v181, 16, v77
    v_lshlrev_b32 v188, 16, v82
    v_and_b32 v189, s14, v82
    v_and_b32 v196, s14, v85
    v_lshlrev_b32 v197, 16, v85
    v_lshlrev_b32 v174, 16, v75
    v_and_b32 v175, s14, v75
    v_and_b32 v182, s14, v76
    v_lshlrev_b32 v183, 16, v76
    v_lshlrev_b32 v190, 16, v83
    v_and_b32 v191, s14, v83
    v_and_b32 v198, s14, v84
    v_lshlrev_b32 v199, 16, v84
    v_pk_fma_f32 v[168:169], v[168:169], s[12:13], v[184:185]
    v_pk_fma_f32 v[176:177], v[192:193], s[12:13], v[176:177]
    v_pk_fma_f32 v[170:171], v[170:171], s[12:13], v[186:187]
    v_pk_fma_f32 v[178:179], v[194:195], s[12:13], v[178:179]
    v_pk_fma_f32 v[172:173], v[172:173], s[12:13], v[188:189]
    v_pk_fma_f32 v[180:181], v[196:197], s[12:13], v[180:181]
    v_pk_fma_f32 v[174:175], v[174:175], s[12:13], v[190:191]
    v_pk_fma_f32 v[182:183], v[198:199], s[12:13], v[182:183]
    v_pk_add_f32 v[184:185], v[168:169], v[176:177]
    v_pk_add_f32 v[192:193], v[168:169], v[176:177] neg_lo:[0,1] neg_hi:[0,1]
    v_pk_add_f32 v[186:187], v[170:171], v[178:179]
    v_pk_add_f32 v[194:195], v[170:171], v[178:179] neg_lo:[0,1] neg_hi:[0,1]
    v_pk_add_f32 v[188:189], v[172:173], v[180:181]
    v_pk_add_f32 v[196:197], v[172:173], v[180:181] neg_lo:[0,1] neg_hi:[0,1]
    v_pk_add_f32 v[190:191], v[174:175], v[182:183]
    v_pk_add_f32 v[198:199], v[174:175], v[182:183] neg_lo:[0,1] neg_hi:[0,1]
    v_cvt_pk_bf16_f32 v200, v184, v185
    v_cvt_pk_bf16_f32 v204, v192, v193
    v_cvt_pk_bf16_f32 v201, v186, v187
    v_cvt_pk_bf16_f32 v205, v194, v195
    v_cvt_pk_bf16_f32 v202, v188, v189
    v_cvt_pk_bf16_f32 v206, v196, v197
    v_cvt_pk_bf16_f32 v203, v190, v191
    v_cvt_pk_bf16_f32 v207, v198, v199
    ds_write_b128 v6, v[200:203] offset:4096
    ds_write_b128 v6, v[204:207] offset:24576
    s_waitcnt lgkmcnt(0)
    s_add_u32 s68, s68, 1
    s_barrier
    s_cmp_lg_u32 s3, 4
    s_cbranch_scc1 L_xp3
    s_getreg_b32 s15, hwreg(HW_REG_XCC_ID, 0, 4)
    v_mov_b32 v200, s68
    v_mov_b32 v201, s15
    v_mov_b32 v202, 0
    s_lshl_b32 s15, s4, 5
    s_add_u32 s15, s15, s5
    s_lshl_b32 s15, s15, 3
    s_add_u32 s15, s15, 36864
    buffer_store_dwordx2 v[200:201], v202, s[56:59], s15 offen sc1
L_xp3:
    s_setprio 1
    s_and_b32 s10, s3, 3
    v_and_b32 v88, 15, v0
    v_lshrrev_b32 v89, 4, v0
    s_lshl_b32 s11, s10, 14
    s_add_u32 s11, s11, 0
    v_lshl_add_u32 v90, v0, 4, s11
    v_cvt_f32_u32 v92, v89
    v_lshl_add_u32 v91, s10, 4, v88
    v_cvt_f32_u32 v91, v91
    v_mul_f32 v94, v91, v92
    v_mul_f32 v94, 0x3e000000, v94
    v_fmamk_f32 v96, v91, 0x00000000, v94
    v_fmamk_f32 v97, v91, 0x3c800000, v94
    v_fmamk_f32 v98, v91, 0x3d000000, v94
    v_fmamk_f32 v99, v91, 0x3d400000, v94
    v_fmamk_f32 v100, v91, 0x3d800000, v94
    v_fmamk_f32 v101, v91, 0x3da00000, v94
    v_fmamk_f32 v102, v91, 0x3dc00000, v94
    v_fmamk_f32 v103, v91, 0x3de00000, v94
    v_sin_f32 v104, v96
    v_sin_f32 v105, v97
    v_sin_f32 v106, v98
    v_sin_f32 v107, v99
    v_sin_f32 v108, v100
    v_sin_f32 v109, v101
    v_sin_f32 v110, v102
    v_sin_f32 v111, v103
    v_cos_f32 v96, v96
    v_cos_f32 v97, v97
    v_cos_f32 v98, v98
    v_cos_f32 v99, v99
    v_cos_f32 v100, v100
    v_cos_f32 v101, v101
    v_cos_f32 v102, v102
    v_cos_f32 v103, v103
    v_cvt_pk_bf16_f32 v116, v104, v105
    v_cvt_pk_bf16_f32 v117, v106, v107
    v_cvt_pk_bf16_f32 v118, v108, v109
    v_cvt_pk_bf16_f32 v119, v110, v111
    v_cvt_pk_bf16_f32 v112, v96, v97
    v_cvt_pk_bf16_f32 v113, v98, v99
    v_cvt_pk_bf16_f32 v114, v100, v101
    v_cvt_pk_bf16_f32 v115, v102, v103
    ds_write_b128 v90, v[112:115] offset:0
    ds_write_b128 v90, v[116:119] offset:2048
    v_mul_f32 v94, v91, v92
    v_mul_f32 v94, 0x3e000000, v94
    v_fmamk_f32 v96, v91, 0x3f000000, v94
    v_fmamk_f32 v97, v91, 0x3f040000, v94
    v_fmamk_f32 v98, v91, 0x3f080000, v94
    v_fmamk_f32 v99, v91, 0x3f0c0000, v94
    v_fmamk_f32 v100, v91, 0x3f100000, v94
    v_fmamk_f32 v101, v91, 0x3f140000, v94
    v_fmamk_f32 v102, v91, 0x3f180000, v94
    v_fmamk_f32 v103, v91, 0x3f1c0000, v94
    v_sin_f32 v104, v96
    v_sin_f32 v105, v97
    v_sin_f32 v106, v98
    v_sin_f32 v107, v99
    v_sin_f32 v108, v100
    v_sin_f32 v109, v101
    v_sin_f32 v110, v102
    v_sin_f32 v111, v103
    v_cos_f32 v96, v96
    v_cos_f32 v97, v97
    v_cos_f32 v98, v98
    v_cos_f32 v99, v99
    v_cos_f32 v100, v100
    v_cos_f32 v101, v101
    v_cos_f32 v102, v102
    v_cos_f32 v103, v103
    v_cvt_pk_bf16_f32 v124, v104, v105
    v_cvt_pk_bf16_f32 v125, v106, v107
    v_cvt_pk_bf16_f32 v126, v108, v109
    v_cvt_pk_bf16_f32 v127, v110, v111
    v_cvt_pk_bf16_f32 v120, v96, v97
    v_cvt_pk_bf16_f32 v121, v98, v99
    v_cvt_pk_bf16_f32 v122, v100, v101
    v_cvt_pk_bf16_f32 v123, v102, v103
    ds_write_b128 v90, v[120:123] offset:1024
    ds_write_b128 v90, v[124:127] offset:3072
    v_mul_f32 v94, v91, v92
    v_mul_f32 v94, 0x3b000000, v94
    v_fmamk_f32 v96, v91, 0x00000000, v94
    v_fmamk_f32 v97, v91, 0x3a000000, v94
    v_fmamk_f32 v98, v91, 0x3a800000, v94
    v_fmamk_f32 v99, v91, 0x3ac00000, v94
    v_fmamk_f32 v100, v91, 0x3c000000, v94
    v_fmamk_f32 v101, v91, 0x3c080000, v94
    v_fmamk_f32 v102, v91, 0x3c100000, v94
    v_fmamk_f32 v103, v91, 0x3c180000, v94
    v_sin_f32 v104, v96
    v_sin_f32 v105, v97
    v_sin_f32 v106, v98
    v_sin_f32 v107, v99
    v_sin_f32 v108, v100
    v_sin_f32 v109, v101
    v_sin_f32 v110, v102
    v_sin_f32 v111, v103
    v_cos_f32 v96, v96
    v_cos_f32 v97, v97
    v_cos_f32 v98, v98
    v_cos_f32 v99, v99
    v_cos_f32 v100, v100
    v_cos_f32 v101, v101
    v_cos_f32 v102, v102
    v_cos_f32 v103, v103
    ds_write_b128 v90, v[96:99] offset:4096
    ds_write_b128 v90, v[104:107] offset:6144
    ds_write_b128 v90, v[100:103] offset:5120
    ds_write_b128 v90, v[108:111] offset:7168
    s_and_b32 s10, s3, 3
    v_and_b32 v88, 15, v0
    v_lshrrev_b32 v89, 4, v0
    s_lshl_b32 s11, s10, 14
    s_add_u32 s11, s11, 8192
    v_lshl_add_u32 v90, v0, 4, s11
    v_cvt_f32_u32 v92, v89
    v_cvt_f32_u32 v93, v88
    v_add_f32 v95, 0x41800000, v93
    v_mul_f32 v94, v93, v92
    v_mul_f32 v94, 0x3e000000, v94
    v_fmamk_f32 v96, v93, 0x00000000, v94
    v_fmamk_f32 v97, v93, 0x3d000000, v94
    v_fmamk_f32 v98, v93, 0x3d800000, v94
    v_fmamk_f32 v99, v93, 0x3dc00000, v94
    v_fmamk_f32 v100, v93, 0x3f000000, v94
    v_fmamk_f32 v101, v93, 0x3f080000, v94
    v_fmamk_f32 v102, v93, 0x3f100000, v94
    v_fmamk_f32 v103, v93, 0x3f180000, v94
    v_sin_f32 v104, v96
    v_sin_f32 v105, v97
    v_sin_f32 v106, v98
    v_sin_f32 v107, v99
    v_sin_f32 v108, v100
    v_sin_f32 v109, v101
    v_sin_f32 v110, v102
    v_sin_f32 v111, v103
    v_cos_f32 v96, v96
    v_cos_f32 v97, v97
    v_cos_f32 v98, v98
    v_cos_f32 v99, v99
    v_cos_f32 v100, v100
    v_cos_f32 v101, v101
    v_cos_f32 v102, v102
    v_cos_f32 v103, v103
    v_cvt_pk_bf16_f32 v116, v104, v105
    v_cvt_pk_bf16_f32 v117, v106, v107
    v_cvt_pk_bf16_f32 v118, v108, v109
    v_cvt_pk_bf16_f32 v119, v110, v111
    v_cvt_pk_bf16_f32 v112, v96, v97
    v_cvt_pk_bf16_f32 v113, v98, v99
    v_cvt_pk_bf16_f32 v114, v100, v101
    v_cvt_pk_bf16_f32 v115, v102, v103
    ds_write_b128 v90, v[112:115] offset:0
    ds_write_b128 v90, v[116:119] offset:2048
    v_mul_f32 v94, v95, v92
    v_mul_f32 v94, 0x3e000000, v94
    v_fmamk_f32 v96, v95, 0x00000000, v94
    v_fmamk_f32 v97, v95, 0x3d000000, v94
    v_fmamk_f32 v98, v95, 0x3d800000, v94
    v_fmamk_f32 v99, v95, 0x3dc00000, v94
    v_fmamk_f32 v100, v95, 0x3f000000, v94
    v_fmamk_f32 v101, v95, 0x3f080000, v94
    v_fmamk_f32 v102, v95, 0x3f100000, v94
    v_fmamk_f32 v103, v95, 0x3f180000, v94
    v_sin_f32 v104, v96
    v_sin_f32 v105, v97
    v_sin_f32 v106, v98
    v_sin_f32 v107, v99
    v_sin_f32 v108, v100
    v_sin_f32 v109, v101
    v_sin_f32 v110, v102
    v_sin_f32 v111, v103
    v_cos_f32 v96, v96
    v_cos_f32 v97, v97
    v_cos_f32 v98, v98
    v_cos_f32 v99, v99
    v_cos_f32 v100, v100
    v_cos_f32 v101, v101
    v_cos_f32 v102, v102
    v_cos_f32 v103, v103
    v_cvt_pk_bf16_f32 v124, v104, v105
    v_cvt_pk_bf16_f32 v125, v106, v107
    v_cvt_pk_bf16_f32 v126, v108, v109
    v_cvt_pk_bf16_f32 v127, v110, v111
    v_cvt_pk_bf16_f32 v120, v96, v97
    v_cvt_pk_bf16_f32 v121, v98, v99
    v_cvt_pk_bf16_f32 v122, v100, v101
    v_cvt_pk_bf16_f32 v123, v102, v103
    ds_write_b128 v90, v[120:123] offset:1024
    ds_write_b128 v90, v[124:127] offset:3072
    v_lshlrev_b32 v94, 2, v89
    v_lshl_add_u32 v94, s10, 4, v94
    v_cvt_f32_u32 v94, v94
    v_mul_f32 v94, 0x3a000000, v94
    v_mul_f32 v96, v93, v94
    v_fmamk_f32 v97, v93, 0x3a000000, v96
    v_fmamk_f32 v98, v93, 0x3a800000, v96
    v_fmamk_f32 v99, v93, 0x3ac00000, v96
    v_mul_f32 v100, v95, v94
    v_fmamk_f32 v101, v95, 0x3a000000, v100
    v_fmamk_f32 v102, v95, 0x3a800000, v100
    v_fmamk_f32 v103, v95, 0x3ac00000, v100
    v_sin_f32 v104, v96
    v_sin_f32 v105, v97
    v_sin_f32 v106, v98
    v_sin_f32 v107, v99
    v_sin_f32 v108, v100
    v_sin_f32 v109, v101
    v_sin_f32 v110, v102
    v_sin_f32 v111, v103
    v_cos_f32 v96, v96
    v_cos_f32 v97, v97
    v_cos_f32 v98, v98
    v_cos_f32 v99, v99
    v_cos_f32 v100, v100
    v_cos_f32 v101, v101
    v_cos_f32 v102, v102
    v_cos_f32 v103, v103
    v_mul_f32 v104, 0x35cccccd, v104
    v_mul_f32 v105, 0x35cccccd, v105
    v_mul_f32 v106, 0x35cccccd, v106
    v_mul_f32 v107, 0x35cccccd, v107
    v_mul_f32 v108, 0x35cccccd, v108
    v_mul_f32 v109, 0x35cccccd, v109
    v_mul_f32 v110, 0x35cccccd, v110
    v_mul_f32 v111, 0x35cccccd, v111
    v_mul_f32 v96, 0x35cccccd, v96
    v_mul_f32 v97, 0x35cccccd, v97
    v_mul_f32 v98, 0x35cccccd, v98
    v_mul_f32 v99, 0x35cccccd, v99
    v_mul_f32 v100, 0x35cccccd, v100
    v_mul_f32 v101, 0x35cccccd, v101
    v_mul_f32 v102, 0x35cccccd, v102
    v_mul_f32 v103, 0x35cccccd, v103
    ds_write_b128 v90, v[96:99] offset:4096
    ds_write_b128 v90, v[104:107] offset:6144
    ds_write_b128 v90, v[100:103] offset:5120
    ds_write_b128 v90, v[108:111] offset:7168
    s_cmp_lg_u32 s7, 0
    s_cbranch_scc1 L_Af_nog
    ds_read_b128 v[88:91], v4 offset:0
    ds_read_b128 v[92:95], v5 offset:256
    ds_read_b128 v[96:99], v4 offset:640
    ds_read_b128 v[100:103], v5 offset:896
    ds_read_b128 v[104:107], v4 offset:64
    ds_read_b128 v[108:111], v5 offset:192
    ds_read_b128 v[112:115], v4 offset:704
    ds_read_b128 v[116:119], v5 offset:832
    ds_read_b128 v[120:123], v4 offset:128
    ds_read_b128 v[124:127], v5 offset:128
    ds_read_b128 v[128:131], v4 offset:768
    ds_read_b128 v[132:135], v5 offset:768
    s_waitcnt lgkmcnt(4)
    ds_read_b128 v[136:139], v4 offset:192
    ds_read_b128 v[140:143], v5 offset:64
    ds_read_b128 v[144:147], v4 offset:832
    ds_read_b128 v[148:151], v5 offset:704
    ds_read_b128 v[152:155], v4 offset:256
    ds_read_b128 v[156:159], v5 offset:0
    ds_read_b128 v[160:163], v4 offset:896
    ds_read_b128 v[164:167], v5 offset:640
    s_waitcnt lgkmcnt(12)
    v_dot2_f32_bf16 v200, v8, v88, 0
    v_dot2_f32_bf16 v201, v9, v89, 0
    v_dot2_f32_bf16 v202, v10, v90, 0
    v_dot2_f32_bf16 v203, v11, v91, 0
    v_dot2_f32_bf16 v200, v12, v92, v200
    v_dot2_f32_bf16 v201, v13, v93, v201
    v_dot2_f32_bf16 v202, v14, v94, v202
    v_dot2_f32_bf16 v203, v15, v95, v203
    v_dot2_f32_bf16 v200, v16, v96, v200
    v_dot2_f32_bf16 v201, v17, v97, v201
    v_dot2_f32_bf16 v202, v18, v98, v202
    v_dot2_f32_bf16 v203, v19, v99, v203
    v_dot2_f32_bf16 v200, v20, v100, v200
    v_dot2_f32_bf16 v201, v21, v101, v201
    v_dot2_f32_bf16 v202, v22, v102, v202
    v_dot2_f32_bf16 v203, v23, v103, v203
    s_waitcnt lgkmcnt(12)
    v_dot2_f32_bf16 v200, v24, v104, v200
    v_dot2_f32_bf16 v201, v25, v105, v201
    v_dot2_f32_bf16 v202, v26, v106, v202
    v_dot2_f32_bf16 v203, v27, v107, v203
    v_dot2_f32_bf16 v200, v28, v108, v200
    v_dot2_f32_bf16 v201, v29, v109, v201
    v_dot2_f32_bf16 v202, v30, v110, v202
    v_dot2_f32_bf16 v203, v31, v111, v203
    v_dot2_f32_bf16 v200, v32, v112, v200
    v_dot2_f32_bf16 v201, v33, v113, v201
    v_dot2_f32_bf16 v202, v34, v114, v202
    v_dot2_f32_bf16 v203, v35, v115, v203
    v_dot2_f32_bf16 v200, v36, v116, v200
    v_dot2_f32_bf16 v201, v37, v117, v201
    v_dot2_f32_bf16 v202, v38, v118, v202
    v_dot2_f32_bf16 v203, v39, v119, v203
    s_waitcnt lgkmcnt(8)
    v_dot2_f32_bf16 v200, v40, v120, v200
    v_dot2_f32_bf16 v201, v41, v121, v201
    v_dot2_f32_bf16 v202, v42, v122, v202
    v_dot2_f32_bf16 v203, v43, v123, v203
    v_dot2_f32_bf16 v200, v44, v124, v200
    v_dot2_f32_bf16 v201, v45, v125, v201
    v_dot2_f32_bf16 v202, v46, v126, v202
    v_dot2_f32_bf16 v203, v47, v127, v203
    v_dot2_f32_bf16 v200, v48, v128, v200
    v_dot2_f32_bf16 v201, v49, v129, v201
    v_dot2_f32_bf16 v202, v50, v130, v202
    v_dot2_f32_bf16 v203, v51, v131, v203
    v_dot2_f32_bf16 v200, v52, v132, v200
    v_dot2_f32_bf16 v201, v53, v133, v201
    v_dot2_f32_bf16 v202, v54, v134, v202
    v_dot2_f32_bf16 v203, v55, v135, v203
    s_waitcnt lgkmcnt(4)
    v_dot2_f32_bf16 v200, v56, v136, v200
    v_dot2_f32_bf16 v201, v57, v137, v201
    v_dot2_f32_bf16 v202, v58, v138, v202
    v_dot2_f32_bf16 v203, v59, v139, v203
    v_dot2_f32_bf16 v200, v60, v140, v200
    v_dot2_f32_bf16 v201, v61, v141, v201
    v_dot2_f32_bf16 v202, v62, v142, v202
    v_dot2_f32_bf16 v203, v63, v143, v203
    v_dot2_f32_bf16 v200, v64, v144, v200
    v_dot2_f32_bf16 v201, v65, v145, v201
    v_dot2_f32_bf16 v202, v66, v146, v202
    v_dot2_f32_bf16 v203, v67, v147, v203
    v_dot2_f32_bf16 v200, v68, v148, v200
    v_dot2_f32_bf16 v201, v69, v149, v201
    v_dot2_f32_bf16 v202, v70, v150, v202
    v_dot2_f32_bf16 v203, v71, v151, v203
    s_waitcnt lgkmcnt(0)
    v_dot2_f32_bf16 v200, v72, v152, v200
    v_dot2_f32_bf16 v201, v73, v153, v201
    v_dot2_f32_bf16 v202, v74, v154, v202
    v_dot2_f32_bf16 v203, v75, v155, v203
    v_dot2_f32_bf16 v200, v76, v156, v200
    v_dot2_f32_bf16 v201, v77, v157, v201
    v_dot2_f32_bf16 v202, v78, v158, v202
    v_dot2_f32_bf16 v203, v79, v159, v203
    v_dot2_f32_bf16 v200, v80, v160, v200
    v_dot2_f32_bf16 v201, v81, v161, v201
    v_dot2_f32_bf16 v202, v82, v162, v202
    v_dot2_f32_bf16 v203, v83, v163, v203
    v_dot2_f32_bf16 v200, v84, v164, v200
    v_dot2_f32_bf16 v201, v85, v165, v201
    v_dot2_f32_bf16 v202, v86, v166, v202
    v_dot2_f32_bf16 v203, v87, v167, v203
    s_nop 0
    v_add_f32 v200, v200, v201
    s_nop 0
    v_add_f32 v202, v202, v203
    v_add_f32 v200, v200, v202
    s_nop 1
    v_add_f32_dpp v200, v200, v200 quad_perm:[1,0,3,2] row_mask:0xf bank_mask:0xf
    s_nop 1
    v_add_f32_dpp v200, v200, v200 quad_perm:[2,3,0,1] row_mask:0xf bank_mask:0xf
    v_cvt_pk_bf16_f32 v200, v200, v200
    v_lshlrev_b32 v200, 16, v200
    v_mul_f32 v200, 0xbfb8aa3b, v200
    v_exp_f32 v200, v200
    s_nop 0
    v_add_f32 v200, 1.0, v200
    v_rcp_f32 v200, v200
    s_nop 0
    v_cvt_pk_bf16_f32 v200, v200, v200
    v_lshlrev_b32 v200, 16, v200
    v_lshlrev_b32 v2, 2, v2
    s_add_u32 s52, s52, 49152
    buffer_store_dword v200, v2, s[56:59], s52 offen sc1
L_Af_nog:
    s_lshr_b32 s6, s5, 3
    s_mul_i32 s67, s6, 5
    s_lshr_b32 s67, s67, 1
    s_lshl2_add_u32 s65, s4, s6
    s_and_b32 s66, s5, 3
    s_bfe_u32 s8, s5, 0x10002
    s_mul_i32 s8, s8, 80
    s_add_u32 s9, s8, 64
    s_lshl4_add_u32 s60, s66, s8
    s_sub_u32 s61, 304, s60
    s_add_u32 s62, 320, s60
    s_sub_u32 s63, 624, s60
    s_sub_u32 s11, 304, s9
    s_bitcmp1_b32 s66, 0
    s_cselect_b32 s64, s11, s9
    s_bitcmp1_b32 s66, 1
    s_cselect_b32 s10, 320, 0
    s_add_u32 s64, s64, s10
    s_bitcmp0_b32 s3, 1
    s_cselect_b32 s72, s32, s34
    s_cselect_b32 s73, s33, s35
    s_mov_b32 s74, 819200
    s_mov_b32 s75, 0x20000
    s_setprio 0
    s_waitcnt lgkmcnt(0)
    s_barrier
    s_branch L_F
L_Ac:
    s_lshr_b32 s10, s3, 1
    s_and_b32 s11, s3, 1
    v_and_b32 v2, 15, v0
    v_lshrrev_b32 v3, 4, v0
    s_mul_i32 s12, s11, 160
    s_add_u32 s12, s12, s7
    v_lshl_add_u32 v4, v2, 1, s12
    v_lshl_add_u32 v6, v3, 4, 1
    v_cvt_f32_u32 v6, v6
    s_cmp_eq_u32 s10, 0
    s_cselect_b32 s13, 0, 0x3e800000
    s_cselect_b32 s14, 0, 320
    v_cmp_eq_u32 vcc, 0, v4
    v_mov_b32 v5, s14
    s_nop 0
    v_cndmask_b32 v5, v4, v5, vcc
    v_cvt_f32_u32 v128, v5
    v_mul_f32 v128, 0x3a4ccccd, v128
    v_fma_f32 v129, v128, v6, s13
    v_mul_f32 v130, 0x42800000, v128
    v_cos_f32 v130, v130
    v_fmamk_f32 v112, v128, 0x00000000, v129
    v_fmamk_f32 v113, v128, 0x40000000, v129
    v_fmamk_f32 v114, v128, 0x40800000, v129
    v_fmamk_f32 v115, v128, 0x40c00000, v129
    v_fmamk_f32 v116, v128, 0x41000000, v129
    v_fmamk_f32 v117, v128, 0x41200000, v129
    v_fmamk_f32 v118, v128, 0x41400000, v129
    v_fmamk_f32 v119, v128, 0x41600000, v129
    v_add_f32 v130, v130, v130
    v_cos_f32 v112, v112
    v_cos_f32 v113, v113
    v_cos_f32 v114, v114
    v_cos_f32 v115, v115
    v_cos_f32 v116, v116
    v_cos_f32 v117, v117
    v_cos_f32 v118, v118
    v_cos_f32 v119, v119
    v_fmamk_f32 v120, v128, 0x42800000, v129
    v_fmamk_f32 v121, v128, 0x42840000, v129
    v_fmamk_f32 v122, v128, 0x42880000, v129
    v_fmamk_f32 v123, v128, 0x428c0000, v129
    v_fmamk_f32 v124, v128, 0x42900000, v129
    v_fmamk_f32 v125, v128, 0x42940000, v129
    v_fmamk_f32 v126, v128, 0x42980000, v129
    v_fmamk_f32 v127, v128, 0x429c0000, v129
    v_cos_f32 v120, v120
    v_cos_f32 v121, v121
    v_cos_f32 v122, v122
    v_cos_f32 v123, v123
    v_cos_f32 v124, v124
    v_cos_f32 v125, v125
    v_cos_f32 v126, v126
    v_cos_f32 v127, v127
    v_cvt_pk_bf16_f32 v12, v112, v113
    v_cvt_pk_bf16_f32 v13, v114, v115
    v_cvt_pk_bf16_f32 v14, v116, v117
    v_cvt_pk_bf16_f32 v15, v118, v119
    v_cvt_pk_bf16_f32 v16, v120, v121
    v_cvt_pk_bf16_f32 v17, v122, v123
    v_cvt_pk_bf16_f32 v18, v124, v125
    v_cvt_pk_bf16_f32 v19, v126, v127
    v_pk_fma_f32 v[112:113], v[120:121], v[130:131], v[112:113] op_sel_hi:[1,0,1] neg_lo:[0,0,1] neg_hi:[0,0,1]
    v_pk_fma_f32 v[114:115], v[122:123], v[130:131], v[114:115] op_sel_hi:[1,0,1] neg_lo:[0,0,1] neg_hi:[0,0,1]
    v_pk_fma_f32 v[116:117], v[124:125], v[130:131], v[116:117] op_sel_hi:[1,0,1] neg_lo:[0,0,1] neg_hi:[0,0,1]
    v_pk_fma_f32 v[118:119], v[126:127], v[130:131], v[118:119] op_sel_hi:[1,0,1] neg_lo:[0,0,1] neg_hi:[0,0,1]
    v_cvt_pk_bf16_f32 v20, v112, v113
    v_cvt_pk_bf16_f32 v21, v114, v115
    v_cvt_pk_bf16_f32 v22, v116, v117
    v_cvt_pk_bf16_f32 v23, v118, v119
    v_pk_fma_f32 v[120:121], v[112:113], v[130:131], v[120:121] op_sel_hi:[1,0,1] neg_lo:[0,0,1] neg_hi:[0,0,1]
    v_pk_fma_f32 v[122:123], v[114:115], v[130:131], v[122:123] op_sel_hi:[1,0,1] neg_lo:[0,0,1] neg_hi:[0,0,1]
    v_pk_fma_f32 v[124:125], v[116:117], v[130:131], v[124:125] op_sel_hi:[1,0,1] neg_lo:[0,0,1] neg_hi:[0,0,1]
    v_pk_fma_f32 v[126:127], v[118:119], v[130:131], v[126:127] op_sel_hi:[1,0,1] neg_lo:[0,0,1] neg_hi:[0,0,1]
    v_cvt_pk_bf16_f32 v24, v120, v121
    v_cvt_pk_bf16_f32 v25, v122, v123
    v_cvt_pk_bf16_f32 v26, v124, v125
    v_cvt_pk_bf16_f32 v27, v126, v127
    v_pk_fma_f32 v[112:113], v[120:121], v[130:131], v[112:113] op_sel_hi:[1,0,1] neg_lo:[0,0,1] neg_hi:[0,0,1]
    v_pk_fma_f32 v[114:115], v[122:123], v[130:131], v[114:115] op_sel_hi:[1,0,1] neg_lo:[0,0,1] neg_hi:[0,0,1]
    v_pk_fma_f32 v[116:117], v[124:125], v[130:131], v[116:117] op_sel_hi:[1,0,1] neg_lo:[0,0,1] neg_hi:[0,0,1]
    v_pk_fma_f32 v[118:119], v[126:127], v[130:131], v[118:119] op_sel_hi:[1,0,1] neg_lo:[0,0,1] neg_hi:[0,0,1]
    v_cvt_pk_bf16_f32 v28, v112, v113
    v_cvt_pk_bf16_f32 v29, v114, v115
    v_cvt_pk_bf16_f32 v30, v116, v117
    v_cvt_pk_bf16_f32 v31, v118, v119
    v_add_u32 v5, 32, v4
    v_cvt_f32_u32 v128, v5
    v_mul_f32 v128, 0x3a4ccccd, v128
    v_fma_f32 v129, v128, v6, s13
    v_mul_f32 v130, 0x42800000, v128
    v_cos_f32 v130, v130
    v_fmamk_f32 v112, v128, 0x00000000, v129
    v_fmamk_f32 v113, v128, 0x40000000, v129
    v_fmamk_f32 v114, v128, 0x40800000, v129
    v_fmamk_f32 v115, v128, 0x40c00000, v129
    v_fmamk_f32 v116, v128, 0x41000000, v129
    v_fmamk_f32 v117, v128, 0x41200000, v129
    v_fmamk_f32 v118, v128, 0x41400000, v129
    v_fmamk_f32 v119, v128, 0x41600000, v129
    v_add_f32 v130, v130, v130
    v_cos_f32 v112, v112
    v_cos_f32 v113, v113
    v_cos_f32 v114, v114
    v_cos_f32 v115, v115
    v_cos_f32 v116, v116
    v_cos_f32 v117, v117
    v_cos_f32 v118, v118
    v_cos_f32 v119, v119
    v_fmamk_f32 v120, v128, 0x42800000, v129
    v_fmamk_f32 v121, v128, 0x42840000, v129
    v_fmamk_f32 v122, v128, 0x42880000, v129
    v_fmamk_f32 v123, v128, 0x428c0000, v129
    v_fmamk_f32 v124, v128, 0x42900000, v129
    v_fmamk_f32 v125, v128, 0x42940000, v129
    v_fmamk_f32 v126, v128, 0x42980000, v129
    v_fmamk_f32 v127, v128, 0x429c0000, v129
    v_cos_f32 v120, v120
    v_cos_f32 v121, v121
    v_cos_f32 v122, v122
    v_cos_f32 v123, v123
    v_cos_f32 v124, v124
    v_cos_f32 v125, v125
    v_cos_f32 v126, v126
    v_cos_f32 v127, v127
    v_cvt_pk_bf16_f32 v32, v112, v113
    v_cvt_pk_bf16_f32 v33, v114, v115
    v_cvt_pk_bf16_f32 v34, v116, v117
    v_cvt_pk_bf16_f32 v35, v118, v119
    v_cvt_pk_bf16_f32 v36, v120, v121
    v_cvt_pk_bf16_f32 v37, v122, v123
    v_cvt_pk_bf16_f32 v38, v124, v125
    v_cvt_pk_bf16_f32 v39, v126, v127
    v_pk_fma_f32 v[112:113], v[120:121], v[130:131], v[112:113] op_sel_hi:[1,0,1] neg_lo:[0,0,1] neg_hi:[0,0,1]
    v_pk_fma_f32 v[114:115], v[122:123], v[130:131], v[114:115] op_sel_hi:[1,0,1] neg_lo:[0,0,1] neg_hi:[0,0,1]
    v_pk_fma_f32 v[116:117], v[124:125], v[130:131], v[116:117] op_sel_hi:[1,0,1] neg_lo:[0,0,1] neg_hi:[0,0,1]
    v_pk_fma_f32 v[118:119], v[126:127], v[130:131], v[118:119] op_sel_hi:[1,0,1] neg_lo:[0,0,1] neg_hi:[0,0,1]
    v_cvt_pk_bf16_f32 v40, v112, v113
    v_cvt_pk_bf16_f32 v41, v114, v115
    v_cvt_pk_bf16_f32 v42, v116, v117
    v_cvt_pk_bf16_f32 v43, v118, v119
    v_pk_fma_f32 v[120:121], v[112:113], v[130:131], v[120:121] op_sel_hi:[1,0,1] neg_lo:[0,0,1] neg_hi:[0,0,1]
    v_pk_fma_f32 v[122:123], v[114:115], v[130:131], v[122:123] op_sel_hi:[1,0,1] neg_lo:[0,0,1] neg_hi:[0,0,1]
    v_pk_fma_f32 v[124:125], v[116:117], v[130:131], v[124:125] op_sel_hi:[1,0,1] neg_lo:[0,0,1] neg_hi:[0,0,1]
    v_pk_fma_f32 v[126:127], v[118:119], v[130:131], v[126:127] op_sel_hi:[1,0,1] neg_lo:[0,0,1] neg_hi:[0,0,1]
    v_cvt_pk_bf16_f32 v44, v120, v121
    v_cvt_pk_bf16_f32 v45, v122, v123
    v_cvt_pk_bf16_f32 v46, v124, v125
    v_cvt_pk_bf16_f32 v47, v126, v127
    v_pk_fma_f32 v[112:113], v[120:121], v[130:131], v[112:113] op_sel_hi:[1,0,1] neg_lo:[0,0,1] neg_hi:[0,0,1]
    v_pk_fma_f32 v[114:115], v[122:123], v[130:131], v[114:115] op_sel_hi:[1,0,1] neg_lo:[0,0,1] neg_hi:[0,0,1]
    v_pk_fma_f32 v[116:117], v[124:125], v[130:131], v[116:117] op_sel_hi:[1,0,1] neg_lo:[0,0,1] neg_hi:[0,0,1]
    v_pk_fma_f32 v[118:119], v[126:127], v[130:131], v[118:119] op_sel_hi:[1,0,1] neg_lo:[0,0,1] neg_hi:[0,0,1]
    v_cvt_pk_bf16_f32 v48, v112, v113
    v_cvt_pk_bf16_f32 v49, v114, v115
    v_cvt_pk_bf16_f32 v50, v116, v117
    v_cvt_pk_bf16_f32 v51, v118, v119
    s_waitcnt lgkmcnt(0)
    s_load_dword s68, s[46:47], 40960
    s_mov_b32 s56, s46
    s_mov_b32 s57, s47
    s_mov_b32 s58, 13336576
    s_mov_b32 s59, 0x20000
    v_add_u32 v5, 64, v4
    v_cvt_f32_u32 v128, v5
    v_mul_f32 v128, 0x3a4ccccd, v128
    v_fma_f32 v129, v128, v6, s13
    v_mul_f32 v130, 0x42800000, v128
    v_cos_f32 v130, v130
    v_fmamk_f32 v112, v128, 0x00000000, v129
    v_fmamk_f32 v113, v128, 0x40000000, v129
    v_fmamk_f32 v114, v128, 0x40800000, v129
    v_fmamk_f32 v115, v128, 0x40c00000, v129
    v_fmamk_f32 v116, v128, 0x41000000, v129
    v_fmamk_f32 v117, v128, 0x41200000, v129
    v_fmamk_f32 v118, v128, 0x41400000, v129
    v_fmamk_f32 v119, v128, 0x41600000, v129
    v_add_f32 v130, v130, v130
    v_cos_f32 v112, v112
    v_cos_f32 v113, v113
    v_cos_f32 v114, v114
    v_cos_f32 v115, v115
    v_cos_f32 v116, v116
    v_cos_f32 v117, v117
    v_cos_f32 v118, v118
    v_cos_f32 v119, v119
    v_fmamk_f32 v120, v128, 0x42800000, v129
    v_fmamk_f32 v121, v128, 0x42840000, v129
    v_fmamk_f32 v122, v128, 0x42880000, v129
    v_fmamk_f32 v123, v128, 0x428c0000, v129
    v_fmamk_f32 v124, v128, 0x42900000, v129
    v_fmamk_f32 v125, v128, 0x42940000, v129
    v_fmamk_f32 v126, v128, 0x42980000, v129
    v_fmamk_f32 v127, v128, 0x429c0000, v129
    v_cos_f32 v120, v120
    v_cos_f32 v121, v121
    v_cos_f32 v122, v122
    v_cos_f32 v123, v123
    v_cos_f32 v124, v124
    v_cos_f32 v125, v125
    v_cos_f32 v126, v126
    v_cos_f32 v127, v127
    v_cvt_pk_bf16_f32 v52, v112, v113
    v_cvt_pk_bf16_f32 v53, v114, v115
    v_cvt_pk_bf16_f32 v54, v116, v117
    v_cvt_pk_bf16_f32 v55, v118, v119
    v_cvt_pk_bf16_f32 v56, v120, v121
    v_cvt_pk_bf16_f32 v57, v122, v123
    v_cvt_pk_bf16_f32 v58, v124, v125
    v_cvt_pk_bf16_f32 v59, v126, v127
    v_pk_fma_f32 v[112:113], v[120:121], v[130:131], v[112:113] op_sel_hi:[1,0,1] neg_lo:[0,0,1] neg_hi:[0,0,1]
    v_pk_fma_f32 v[114:115], v[122:123], v[130:131], v[114:115] op_sel_hi:[1,0,1] neg_lo:[0,0,1] neg_hi:[0,0,1]
    v_pk_fma_f32 v[116:117], v[124:125], v[130:131], v[116:117] op_sel_hi:[1,0,1] neg_lo:[0,0,1] neg_hi:[0,0,1]
    v_pk_fma_f32 v[118:119], v[126:127], v[130:131], v[118:119] op_sel_hi:[1,0,1] neg_lo:[0,0,1] neg_hi:[0,0,1]
    v_cvt_pk_bf16_f32 v60, v112, v113
    v_cvt_pk_bf16_f32 v61, v114, v115
    v_cvt_pk_bf16_f32 v62, v116, v117
    v_cvt_pk_bf16_f32 v63, v118, v119
    v_pk_fma_f32 v[120:121], v[112:113], v[130:131], v[120:121] op_sel_hi:[1,0,1] neg_lo:[0,0,1] neg_hi:[0,0,1]
    v_pk_fma_f32 v[122:123], v[114:115], v[130:131], v[122:123] op_sel_hi:[1,0,1] neg_lo:[0,0,1] neg_hi:[0,0,1]
    v_pk_fma_f32 v[124:125], v[116:117], v[130:131], v[124:125] op_sel_hi:[1,0,1] neg_lo:[0,0,1] neg_hi:[0,0,1]
    v_pk_fma_f32 v[126:127], v[118:119], v[130:131], v[126:127] op_sel_hi:[1,0,1] neg_lo:[0,0,1] neg_hi:[0,0,1]
    v_cvt_pk_bf16_f32 v64, v120, v121
    v_cvt_pk_bf16_f32 v65, v122, v123
    v_cvt_pk_bf16_f32 v66, v124, v125
    v_cvt_pk_bf16_f32 v67, v126, v127
    v_pk_fma_f32 v[112:113], v[120:121], v[130:131], v[112:113] op_sel_hi:[1,0,1] neg_lo:[0,0,1] neg_hi:[0,0,1]
    v_pk_fma_f32 v[114:115], v[122:123], v[130:131], v[114:115] op_sel_hi:[1,0,1] neg_lo:[0,0,1] neg_hi:[0,0,1]
    v_pk_fma_f32 v[116:117], v[124:125], v[130:131], v[116:117] op_sel_hi:[1,0,1] neg_lo:[0,0,1] neg_hi:[0,0,1]
    v_pk_fma_f32 v[118:119], v[126:127], v[130:131], v[118:119] op_sel_hi:[1,0,1] neg_lo:[0,0,1] neg_hi:[0,0,1]
    v_cvt_pk_bf16_f32 v68, v112, v113
    v_cvt_pk_bf16_f32 v69, v114, v115
    v_cvt_pk_bf16_f32 v70, v116, v117
    v_cvt_pk_bf16_f32 v71, v118, v119
    v_add_u32 v5, 96, v4
    v_cvt_f32_u32 v128, v5
    v_mul_f32 v128, 0x3a4ccccd, v128
    v_fma_f32 v129, v128, v6, s13
    v_mul_f32 v130, 0x42800000, v128
    v_cos_f32 v130, v130
    v_fmamk_f32 v112, v128, 0x00000000, v129
    v_fmamk_f32 v113, v128, 0x40000000, v129
    v_fmamk_f32 v114, v128, 0x40800000, v129
    v_fmamk_f32 v115, v128, 0x40c00000, v129
    v_fmamk_f32 v116, v128, 0x41000000, v129
    v_fmamk_f32 v117, v128, 0x41200000, v129
    v_fmamk_f32 v118, v128, 0x41400000, v129
    v_fmamk_f32 v119, v128, 0x41600000, v129
    v_add_f32 v130, v130, v130
    v_cos_f32 v112, v112
    v_cos_f32 v113, v113
    v_cos_f32 v114, v114
    v_cos_f32 v115, v115
    v_cos_f32 v116, v116
    v_cos_f32 v117, v117
    v_cos_f32 v118, v118
    v_cos_f32 v119, v119
    v_fmamk_f32 v120, v128, 0x42800000, v129
    v_fmamk_f32 v121, v128, 0x42840000, v129
    v_fmamk_f32 v122, v128, 0x42880000, v129
    v_fmamk_f32 v123, v128, 0x428c0000, v129
    v_fmamk_f32 v124, v128, 0x42900000, v129
    v_fmamk_f32 v125, v128, 0x42940000, v129
    v_fmamk_f32 v126, v128, 0x42980000, v129
    v_fmamk_f32 v127, v128, 0x429c0000, v129
    v_cos_f32 v120, v120
    v_cos_f32 v121, v121
    v_cos_f32 v122, v122
    v_cos_f32 v123, v123
    v_cos_f32 v124, v124
    v_cos_f32 v125, v125
    v_cos_f32 v126, v126
    v_cos_f32 v127, v127
    v_cvt_pk_bf16_f32 v72, v112, v113
    v_cvt_pk_bf16_f32 v73, v114, v115
    v_cvt_pk_bf16_f32 v74, v116, v117
    v_cvt_pk_bf16_f32 v75, v118, v119
    v_cvt_pk_bf16_f32 v76, v120, v121
    v_cvt_pk_bf16_f32 v77, v122, v123
    v_cvt_pk_bf16_f32 v78, v124, v125
    v_cvt_pk_bf16_f32 v79, v126, v127
    v_pk_fma_f32 v[112:113], v[120:121], v[130:131], v[112:113] op_sel_hi:[1,0,1] neg_lo:[0,0,1] neg_hi:[0,0,1]
    v_pk_fma_f32 v[114:115], v[122:123], v[130:131], v[114:115] op_sel_hi:[1,0,1] neg_lo:[0,0,1] neg_hi:[0,0,1]
    v_pk_fma_f32 v[116:117], v[124:125], v[130:131], v[116:117] op_sel_hi:[1,0,1] neg_lo:[0,0,1] neg_hi:[0,0,1]
    v_pk_fma_f32 v[118:119], v[126:127], v[130:131], v[118:119] op_sel_hi:[1,0,1] neg_lo:[0,0,1] neg_hi:[0,0,1]
    v_cvt_pk_bf16_f32 v80, v112, v113
    v_cvt_pk_bf16_f32 v81, v114, v115
    v_cvt_pk_bf16_f32 v82, v116, v117
    v_cvt_pk_bf16_f32 v83, v118, v119
    v_pk_fma_f32 v[120:121], v[112:113], v[130:131], v[120:121] op_sel_hi:[1,0,1] neg_lo:[0,0,1] neg_hi:[0,0,1]
    v_pk_fma_f32 v[122:123], v[114:115], v[130:131], v[122:123] op_sel_hi:[1,0,1] neg_lo:[0,0,1] neg_hi:[0,0,1]
    v_pk_fma_f32 v[124:125], v[116:117], v[130:131], v[124:125] op_sel_hi:[1,0,1] neg_lo:[0,0,1] neg_hi:[0,0,1]
    v_pk_fma_f32 v[126:127], v[118:119], v[130:131], v[126:127] op_sel_hi:[1,0,1] neg_lo:[0,0,1] neg_hi:[0,0,1]
    v_cvt_pk_bf16_f32 v84, v120, v121
    v_cvt_pk_bf16_f32 v85, v122, v123
    v_cvt_pk_bf16_f32 v86, v124, v125
    v_cvt_pk_bf16_f32 v87, v126, v127
    v_pk_fma_f32 v[112:113], v[120:121], v[130:131], v[112:113] op_sel_hi:[1,0,1] neg_lo:[0,0,1] neg_hi:[0,0,1]
    v_pk_fma_f32 v[114:115], v[122:123], v[130:131], v[114:115] op_sel_hi:[1,0,1] neg_lo:[0,0,1] neg_hi:[0,0,1]
    v_pk_fma_f32 v[116:117], v[124:125], v[130:131], v[116:117] op_sel_hi:[1,0,1] neg_lo:[0,0,1] neg_hi:[0,0,1]
    v_pk_fma_f32 v[118:119], v[126:127], v[130:131], v[118:119] op_sel_hi:[1,0,1] neg_lo:[0,0,1] neg_hi:[0,0,1]
    v_cvt_pk_bf16_f32 v88, v112, v113
    v_cvt_pk_bf16_f32 v89, v114, v115
    v_cvt_pk_bf16_f32 v90, v116, v117
    v_cvt_pk_bf16_f32 v91, v118, v119
    v_add_u32 v5, 128, v4
    v_cvt_f32_u32 v128, v5
    v_mul_f32 v128, 0x3a4ccccd, v128
    v_fma_f32 v129, v128, v6, s13
    v_mul_f32 v130, 0x42800000, v128
    v_cos_f32 v130, v130
    v_fmamk_f32 v112, v128, 0x00000000, v129
    v_fmamk_f32 v113, v128, 0x40000000, v129
    v_fmamk_f32 v114, v128, 0x40800000, v129
    v_fmamk_f32 v115, v128, 0x40c00000, v129
    v_fmamk_f32 v116, v128, 0x41000000, v129
    v_fmamk_f32 v117, v128, 0x41200000, v129
    v_fmamk_f32 v118, v128, 0x41400000, v129
    v_fmamk_f32 v119, v128, 0x41600000, v129
    v_add_f32 v130, v130, v130
    v_cos_f32 v112, v112
    v_cos_f32 v113, v113
    v_cos_f32 v114, v114
    v_cos_f32 v115, v115
    v_cos_f32 v116, v116
    v_cos_f32 v117, v117
    v_cos_f32 v118, v118
    v_cos_f32 v119, v119
    v_fmamk_f32 v120, v128, 0x42800000, v129
    v_fmamk_f32 v121, v128, 0x42840000, v129
    v_fmamk_f32 v122, v128, 0x42880000, v129
    v_fmamk_f32 v123, v128, 0x428c0000, v129
    v_fmamk_f32 v124, v128, 0x42900000, v129
    v_fmamk_f32 v125, v128, 0x42940000, v129
    v_fmamk_f32 v126, v128, 0x42980000, v129
    v_fmamk_f32 v127, v128, 0x429c0000, v129
    v_cos_f32 v120, v120
    v_cos_f32 v121, v121
    v_cos_f32 v122, v122
    v_cos_f32 v123, v123
    v_cos_f32 v124, v124
    v_cos_f32 v125, v125
    v_cos_f32 v126, v126
    v_cos_f32 v127, v127
    v_cvt_pk_bf16_f32 v92, v112, v113
    v_cvt_pk_bf16_f32 v93, v114, v115
    v_cvt_pk_bf16_f32 v94, v116, v117
    v_cvt_pk_bf16_f32 v95, v118, v119
    v_cvt_pk_bf16_f32 v96, v120, v121
    v_cvt_pk_bf16_f32 v97, v122, v123
    v_cvt_pk_bf16_f32 v98, v124, v125
    v_cvt_pk_bf16_f32 v99, v126, v127
    v_pk_fma_f32 v[112:113], v[120:121], v[130:131], v[112:113] op_sel_hi:[1,0,1] neg_lo:[0,0,1] neg_hi:[0,0,1]
    v_pk_fma_f32 v[114:115], v[122:123], v[130:131], v[114:115] op_sel_hi:[1,0,1] neg_lo:[0,0,1] neg_hi:[0,0,1]
    v_pk_fma_f32 v[116:117], v[124:125], v[130:131], v[116:117] op_sel_hi:[1,0,1] neg_lo:[0,0,1] neg_hi:[0,0,1]
    v_pk_fma_f32 v[118:119], v[126:127], v[130:131], v[118:119] op_sel_hi:[1,0,1] neg_lo:[0,0,1] neg_hi:[0,0,1]
    v_cvt_pk_bf16_f32 v100, v112, v113
    v_cvt_pk_bf16_f32 v101, v114, v115
    v_cvt_pk_bf16_f32 v102, v116, v117
    v_cvt_pk_bf16_f32 v103, v118, v119
    v_pk_fma_f32 v[120:121], v[112:113], v[130:131], v[120:121] op_sel_hi:[1,0,1] neg_lo:[0,0,1] neg_hi:[0,0,1]
    v_pk_fma_f32 v[122:123], v[114:115], v[130:131], v[122:123] op_sel_hi:[1,0,1] neg_lo:[0,0,1] neg_hi:[0,0,1]
    v_pk_fma_f32 v[124:125], v[116:117], v[130:131], v[124:125] op_sel_hi:[1,0,1] neg_lo:[0,0,1] neg_hi:[0,0,1]
    v_pk_fma_f32 v[126:127], v[118:119], v[130:131], v[126:127] op_sel_hi:[1,0,1] neg_lo:[0,0,1] neg_hi:[0,0,1]
    v_cvt_pk_bf16_f32 v104, v120, v121
    v_cvt_pk_bf16_f32 v105, v122, v123
    v_cvt_pk_bf16_f32 v106, v124, v125
    v_cvt_pk_bf16_f32 v107, v126, v127
    v_pk_fma_f32 v[112:113], v[120:121], v[130:131], v[112:113] op_sel_hi:[1,0,1] neg_lo:[0,0,1] neg_hi:[0,0,1]
    v_pk_fma_f32 v[114:115], v[122:123], v[130:131], v[114:115] op_sel_hi:[1,0,1] neg_lo:[0,0,1] neg_hi:[0,0,1]
    v_pk_fma_f32 v[116:117], v[124:125], v[130:131], v[116:117] op_sel_hi:[1,0,1] neg_lo:[0,0,1] neg_hi:[0,0,1]
    v_pk_fma_f32 v[118:119], v[126:127], v[130:131], v[118:119] op_sel_hi:[1,0,1] neg_lo:[0,0,1] neg_hi:[0,0,1]
    v_cvt_pk_bf16_f32 v108, v112, v113
    v_cvt_pk_bf16_f32 v109, v114, v115
    v_cvt_pk_bf16_f32 v110, v116, v117
    v_cvt_pk_bf16_f32 v111, v118, v119
    v_lshlrev_b32 v8, 1, v3
    v_xor_b32 v8, v8, v2
    v_lshlrev_b32 v8, 4, v8
    v_lshl_add_u32 v8, v3, 8, v8
    s_mul_i32 s12, s10, 20480
    s_add_u32 s12, s12, 122880
    v_add_u32 v8, s12, v8
    v_lshlrev_b32 v7, 15, v3
    v_lshl_add_u32 v7, v2, 4, v7
    s_lshl1_add_u32 s12, s7, s11
    s_mul_i32 s12, s12, 655360
    s_lshl_b32 s13, s10, 13
    s_add_u32 s12, s12, s13
    s_lshl_b32 s13, s6, 8
    s_add_u32 s12, s12, s13
    s_add_u32 s12, s12, 221184
    v_mov_b32 v112, 94208
    v_mov_b32 v113, 0
    ds_write_b32 v112, v113
    s_waitcnt lgkmcnt(0)
    s_add_u32 s68, s68, 1
    s_barrier
    ds_read_b128 v[132:135], v8 offset:0
    ds_read_b128 v[136:139], v8 offset:5120
    ds_read_b128 v[140:143], v8 offset:10240
    ds_read_b128 v[144:147], v8 offset:15360
    ds_read_b128 v[148:151], v8 offset:1024
    ds_read_b128 v[152:155], v8 offset:6144
    ds_read_b128 v[156:159], v8 offset:11264
    ds_read_b128 v[160:163], v8 offset:16384
    ds_read_b128 v[164:167], v8 offset:2048
    ds_read_b128 v[168:171], v8 offset:7168
    ds_read_b128 v[172:175], v8 offset:12288
    ds_read_b128 v[176:179], v8 offset:17408
    s_waitcnt lgkmcnt(6)
    ds_read_b128 v[180:183], v8 offset:3072
    ds_read_b128 v[184:187], v8 offset:8192
    ds_read_b128 v[188:191], v8 offset:13312
    ds_read_b128 v[192:195], v8 offset:18432
    ds_read_b128 v[196:199], v8 offset:4096
    ds_read_b128 v[200:203], v8 offset:9216
    ds_read_b128 v[204:207], v8 offset:14336
    ds_read_b128 v[208:211], v8 offset:19456
    s_waitcnt lgkmcnt(15)
    v_mfma_f32_16x16x32_bf16 v[212:215], v[12:15], v[132:135], 0
    v_mfma_f32_16x16x32_bf16 v[216:219], v[12:15], v[136:139], 0
    v_mfma_f32_16x16x32_bf16 v[220:223], v[12:15], v[140:143], 0
    v_mfma_f32_16x16x32_bf16 v[224:227], v[12:15], v[144:147], 0
    s_waitcnt lgkmcnt(12)
    v_mfma_f32_16x16x32_bf16 v[212:215], v[16:19], v[148:151], v[212:215]
    v_mfma_f32_16x16x32_bf16 v[216:219], v[16:19], v[152:155], v[216:219]
    v_mfma_f32_16x16x32_bf16 v[220:223], v[16:19], v[156:159], v[220:223]
    v_mfma_f32_16x16x32_bf16 v[224:227], v[16:19], v[160:163], v[224:227]
    s_waitcnt lgkmcnt(8)
    v_mfma_f32_16x16x32_bf16 v[212:215], v[20:23], v[164:167], v[212:215]
    v_mfma_f32_16x16x32_bf16 v[216:219], v[20:23], v[168:171], v[216:219]
    v_mfma_f32_16x16x32_bf16 v[220:223], v[20:23], v[172:175], v[220:223]
    v_mfma_f32_16x16x32_bf16 v[224:227], v[20:23], v[176:179], v[224:227]
    s_waitcnt lgkmcnt(4)
    v_mfma_f32_16x16x32_bf16 v[212:215], v[24:27], v[180:183], v[212:215]
    v_mfma_f32_16x16x32_bf16 v[216:219], v[24:27], v[184:187], v[216:219]
    v_mfma_f32_16x16x32_bf16 v[220:223], v[24:27], v[188:191], v[220:223]
    v_mfma_f32_16x16x32_bf16 v[224:227], v[24:27], v[192:195], v[224:227]
    s_waitcnt lgkmcnt(0)
    v_mfma_f32_16x16x32_bf16 v[212:215], v[28:31], v[196:199], v[212:215]
    v_mfma_f32_16x16x32_bf16 v[216:219], v[28:31], v[200:203], v[216:219]
    v_mfma_f32_16x16x32_bf16 v[220:223], v[28:31], v[204:207], v[220:223]
    v_mfma_f32_16x16x32_bf16 v[224:227], v[28:31], v[208:211], v[224:227]
    v_mfma_f32_16x16x32_bf16 v[228:231], v[32:35], v[132:135], 0
    v_mfma_f32_16x16x32_bf16 v[232:235], v[32:35], v[136:139], 0
    v_mfma_f32_16x16x32_bf16 v[236:239], v[32:35], v[140:143], 0
    v_mfma_f32_16x16x32_bf16 v[240:243], v[32:35], v[144:147], 0
    v_mfma_f32_16x16x32_bf16 v[228:231], v[36:39], v[148:151], v[228:231]
    v_mfma_f32_16x16x32_bf16 v[232:235], v[36:39], v[152:155], v[232:235]
    v_mfma_f32_16x16x32_bf16 v[236:239], v[36:39], v[156:159], v[236:239]
    v_mfma_f32_16x16x32_bf16 v[240:243], v[36:39], v[160:163], v[240:243]
    v_cvt_pk_bf16_f32 v12, v212, v216
    v_cvt_pk_bf16_f32 v13, v220, v224
    v_cvt_pk_bf16_f32 v14, v213, v217
    v_cvt_pk_bf16_f32 v15, v221, v225
    buffer_store_dwordx4 v[12:15], v7, s[56:59], s12 offen sc1
    s_add_u32 s12, s12, 16384
    v_cvt_pk_bf16_f32 v16, v214, v218
    v_cvt_pk_bf16_f32 v17, v222, v226
    v_cvt_pk_bf16_f32 v18, v215, v219
    v_cvt_pk_bf16_f32 v19, v223, v227
    buffer_store_dwordx4 v[16:19], v7, s[56:59], s12 offen sc1
    s_add_u32 s12, s12, 114688
    v_mfma_f32_16x16x32_bf16 v[228:231], v[40:43], v[164:167], v[228:231]
    v_mfma_f32_16x16x32_bf16 v[232:235], v[40:43], v[168:171], v[232:235]
    v_mfma_f32_16x16x32_bf16 v[236:239], v[40:43], v[172:175], v[236:239]
    v_mfma_f32_16x16x32_bf16 v[240:243], v[40:43], v[176:179], v[240:243]
    v_mfma_f32_16x16x32_bf16 v[228:231], v[44:47], v[180:183], v[228:231]
    v_mfma_f32_16x16x32_bf16 v[232:235], v[44:47], v[184:187], v[232:235]
    v_mfma_f32_16x16x32_bf16 v[236:239], v[44:47], v[188:191], v[236:239]
    v_mfma_f32_16x16x32_bf16 v[240:243], v[44:47], v[192:195], v[240:243]
    v_mfma_f32_16x16x32_bf16 v[228:231], v[48:51], v[196:199], v[228:231]
    v_mfma_f32_16x16x32_bf16 v[232:235], v[48:51], v[200:203], v[232:235]
    v_mfma_f32_16x16x32_bf16 v[236:239], v[48:51], v[204:207], v[236:239]
    v_mfma_f32_16x16x32_bf16 v[240:243], v[48:51], v[208:211], v[240:243]
    v_mfma_f32_16x16x32_bf16 v[212:215], v[52:55], v[132:135], 0
    v_mfma_f32_16x16x32_bf16 v[216:219], v[52:55], v[136:139], 0
    v_mfma_f32_16x16x32_bf16 v[220:223], v[52:55], v[140:143], 0
    v_mfma_f32_16x16x32_bf16 v[224:227], v[52:55], v[144:147], 0
    v_mfma_f32_16x16x32_bf16 v[212:215], v[56:59], v[148:151], v[212:215]
    v_mfma_f32_16x16x32_bf16 v[216:219], v[56:59], v[152:155], v[216:219]
    v_mfma_f32_16x16x32_bf16 v[220:223], v[56:59], v[156:159], v[220:223]
    v_mfma_f32_16x16x32_bf16 v[224:227], v[56:59], v[160:163], v[224:227]
    v_cvt_pk_bf16_f32 v32, v228, v232
    v_cvt_pk_bf16_f32 v33, v236, v240
    v_cvt_pk_bf16_f32 v34, v229, v233
    v_cvt_pk_bf16_f32 v35, v237, v241
    buffer_store_dwordx4 v[32:35], v7, s[56:59], s12 offen sc1
    s_add_u32 s12, s12, 16384
    v_cvt_pk_bf16_f32 v36, v230, v234
    v_cvt_pk_bf16_f32 v37, v238, v242
    v_cvt_pk_bf16_f32 v38, v231, v235
    v_cvt_pk_bf16_f32 v39, v239, v243
    buffer_store_dwordx4 v[36:39], v7, s[56:59], s12 offen sc1
    s_add_u32 s12, s12, 114688
    v_mfma_f32_16x16x32_bf16 v[212:215], v[60:63], v[164:167], v[212:215]
    v_mfma_f32_16x16x32_bf16 v[216:219], v[60:63], v[168:171], v[216:219]
    v_mfma_f32_16x16x32_bf16 v[220:223], v[60:63], v[172:175], v[220:223]
    v_mfma_f32_16x16x32_bf16 v[224:227], v[60:63], v[176:179], v[224:227]
    v_mfma_f32_16x16x32_bf16 v[212:215], v[64:67], v[180:183], v[212:215]
    v_mfma_f32_16x16x32_bf16 v[216:219], v[64:67], v[184:187], v[216:219]
    v_mfma_f32_16x16x32_bf16 v[220:223], v[64:67], v[188:191], v[220:223]
    v_mfma_f32_16x16x32_bf16 v[224:227], v[64:67], v[192:195], v[224:227]
    v_mfma_f32_16x16x32_bf16 v[212:215], v[68:71], v[196:199], v[212:215]
    v_mfma_f32_16x16x32_bf16 v[216:219], v[68:71], v[200:203], v[216:219]
    v_mfma_f32_16x16x32_bf16 v[220:223], v[68:71], v[204:207], v[220:223]
    v_mfma_f32_16x16x32_bf16 v[224:227], v[68:71], v[208:211], v[224:227]
    v_mfma_f32_16x16x32_bf16 v[228:231], v[72:75], v[132:135], 0
    v_mfma_f32_16x16x32_bf16 v[232:235], v[72:75], v[136:139], 0
    v_mfma_f32_16x16x32_bf16 v[236:239], v[72:75], v[140:143], 0
    v_mfma_f32_16x16x32_bf16 v[240:243], v[72:75], v[144:147], 0
    v_mfma_f32_16x16x32_bf16 v[228:231], v[76:79], v[148:151], v[228:231]
    v_mfma_f32_16x16x32_bf16 v[232:235], v[76:79], v[152:155], v[232:235]
    v_mfma_f32_16x16x32_bf16 v[236:239], v[76:79], v[156:159], v[236:239]
    v_mfma_f32_16x16x32_bf16 v[240:243], v[76:79], v[160:163], v[240:243]
    v_cvt_pk_bf16_f32 v52, v212, v216
    v_cvt_pk_bf16_f32 v53, v220, v224
    v_cvt_pk_bf16_f32 v54, v213, v217
    v_cvt_pk_bf16_f32 v55, v221, v225
    buffer_store_dwordx4 v[52:55], v7, s[56:59], s12 offen sc1
    s_add_u32 s12, s12, 16384
    v_cvt_pk_bf16_f32 v56, v214, v218
    v_cvt_pk_bf16_f32 v57, v222, v226
    v_cvt_pk_bf16_f32 v58, v215, v219
    v_cvt_pk_bf16_f32 v59, v223, v227
    buffer_store_dwordx4 v[56:59], v7, s[56:59], s12 offen sc1
    s_add_u32 s12, s12, 114688
    v_mfma_f32_16x16x32_bf16 v[228:231], v[80:83], v[164:167], v[228:231]
    v_mfma_f32_16x16x32_bf16 v[232:235], v[80:83], v[168:171], v[232:235]
    v_mfma_f32_16x16x32_bf16 v[236:239], v[80:83], v[172:175], v[236:239]
    v_mfma_f32_16x16x32_bf16 v[240:243], v[80:83], v[176:179], v[240:243]
    v_mfma_f32_16x16x32_bf16 v[228:231], v[84:87], v[180:183], v[228:231]
    v_mfma_f32_16x16x32_bf16 v[232:235], v[84:87], v[184:187], v[232:235]
    v_mfma_f32_16x16x32_bf16 v[236:239], v[84:87], v[188:191], v[236:239]
    v_mfma_f32_16x16x32_bf16 v[240:243], v[84:87], v[192:195], v[240:243]
    v_mfma_f32_16x16x32_bf16 v[228:231], v[88:91], v[196:199], v[228:231]
    v_mfma_f32_16x16x32_bf16 v[232:235], v[88:91], v[200:203], v[232:235]
    v_mfma_f32_16x16x32_bf16 v[236:239], v[88:91], v[204:207], v[236:239]
    v_mfma_f32_16x16x32_bf16 v[240:243], v[88:91], v[208:211], v[240:243]
    v_mfma_f32_16x16x32_bf16 v[212:215], v[92:95], v[132:135], 0
    v_mfma_f32_16x16x32_bf16 v[216:219], v[92:95], v[136:139], 0
    v_mfma_f32_16x16x32_bf16 v[220:223], v[92:95], v[140:143], 0
    v_mfma_f32_16x16x32_bf16 v[224:227], v[92:95], v[144:147], 0
    v_mfma_f32_16x16x32_bf16 v[212:215], v[96:99], v[148:151], v[212:215]
    v_mfma_f32_16x16x32_bf16 v[216:219], v[96:99], v[152:155], v[216:219]
    v_mfma_f32_16x16x32_bf16 v[220:223], v[96:99], v[156:159], v[220:223]
    v_mfma_f32_16x16x32_bf16 v[224:227], v[96:99], v[160:163], v[224:227]
    v_cvt_pk_bf16_f32 v72, v228, v232
    v_cvt_pk_bf16_f32 v73, v236, v240
    v_cvt_pk_bf16_f32 v74, v229, v233
    v_cvt_pk_bf16_f32 v75, v237, v241
    buffer_store_dwordx4 v[72:75], v7, s[56:59], s12 offen sc1
    s_add_u32 s12, s12, 16384
    v_cvt_pk_bf16_f32 v76, v230, v234
    v_cvt_pk_bf16_f32 v77, v238, v242
    v_cvt_pk_bf16_f32 v78, v231, v235
    v_cvt_pk_bf16_f32 v79, v239, v243
    buffer_store_dwordx4 v[76:79], v7, s[56:59], s12 offen sc1
    s_add_u32 s12, s12, 114688
    v_mfma_f32_16x16x32_bf16 v[212:215], v[100:103], v[164:167], v[212:215]
    v_mfma_f32_16x16x32_bf16 v[216:219], v[100:103], v[168:171], v[216:219]
    v_mfma_f32_16x16x32_bf16 v[220:223], v[100:103], v[172:175], v[220:223]
    v_mfma_f32_16x16x32_bf16 v[224:227], v[100:103], v[176:179], v[224:227]
    v_mfma_f32_16x16x32_bf16 v[212:215], v[104:107], v[180:183], v[212:215]
    v_mfma_f32_16x16x32_bf16 v[216:219], v[104:107], v[184:187], v[216:219]
    v_mfma_f32_16x16x32_bf16 v[220:223], v[104:107], v[188:191], v[220:223]
    v_mfma_f32_16x16x32_bf16 v[224:227], v[104:107], v[192:195], v[224:227]
    v_mfma_f32_16x16x32_bf16 v[212:215], v[108:111], v[196:199], v[212:215]
    v_mfma_f32_16x16x32_bf16 v[216:219], v[108:111], v[200:203], v[216:219]
    v_mfma_f32_16x16x32_bf16 v[220:223], v[108:111], v[204:207], v[220:223]
    v_mfma_f32_16x16x32_bf16 v[224:227], v[108:111], v[208:211], v[224:227]
    s_nop 5
    v_cvt_pk_bf16_f32 v92, v212, v216
    s_nop 0
    v_cvt_pk_bf16_f32 v93, v220, v224
    v_cvt_pk_bf16_f32 v94, v213, v217
    v_cvt_pk_bf16_f32 v95, v221, v225
    buffer_store_dwordx4 v[92:95], v7, s[56:59], s12 offen sc1
    s_add_u32 s12, s12, 16384
    v_cvt_pk_bf16_f32 v96, v214, v218
    v_cvt_pk_bf16_f32 v97, v222, v226
    v_cvt_pk_bf16_f32 v98, v215, v219
    v_cvt_pk_bf16_f32 v99, v223, v227
    buffer_store_dwordx4 v[96:99], v7, s[56:59], s12 offen sc1
    s_add_u32 s12, s12, 114688
    s_lshr_b32 s6, s5, 3
    s_mul_i32 s67, s6, 5
    s_lshr_b32 s67, s67, 1
    s_lshl2_add_u32 s65, s4, s6
    s_and_b32 s66, s5, 3
    s_bfe_u32 s8, s5, 0x10002
    s_mul_i32 s8, s8, 80
    s_add_u32 s9, s8, 64
    s_lshl4_add_u32 s60, s66, s8
    s_sub_u32 s61, 304, s60
    s_add_u32 s62, 320, s60
    s_sub_u32 s63, 624, s60
    s_sub_u32 s11, 304, s9
    s_bitcmp1_b32 s66, 0
    s_cselect_b32 s64, s11, s9
    s_bitcmp1_b32 s66, 1
    s_cselect_b32 s10, 320, 0
    s_add_u32 s64, s64, s10
    s_bitcmp0_b32 s3, 1
    s_cselect_b32 s72, s32, s34
    s_cselect_b32 s73, s33, s35
    s_mov_b32 s74, 819200
    s_mov_b32 s75, 0x20000
    s_sub_u32 s6, 31, s5
    s_lshl3_add_u32 s6, s6, s4
    v_mov_b32 v112, 94208
    v_mov_b32 v113, 1
    s_mov_b64 exec, 1
    s_waitcnt vmcnt(0)
    ds_add_rtn_u32 v113, v112, v113
    s_waitcnt lgkmcnt(0)
    v_readfirstlane_b32 s10, v113
    s_mov_b64 exec, -1
    s_cmp_lg_u32 s10, 3
    s_cbranch_scc1 L_rf4
    v_mov_b32 v112, s68
    s_lshl_b32 s15, s6, 7
    v_mov_b32 v113, 0
    buffer_store_dword v112, v113, s[56:59], s15 offen sc1
L_rf4:
    s_barrier
    s_branch L_F
L_W:
    s_getpc_b64 s[52:53]
L_pc5:
    s_sub_u32 s52, s52, L_pc5-gated_mix__spectral_gfnet__ssm_conv_s5__prompt_kernel
    s_subb_u32 s53, s53, 0
    s_mov_b32 s54, L_code_end-gated_mix__spectral_gfnet__ssm_conv_s5__prompt_kernel
    s_mov_b32 s55, 0x20000
    s_sub_u32 s15, s5, 28
    s_lshl3_add_u32 s15, s15, s3
    s_lshl_b32 s15, s15, 10
    v_lshlrev_b32 v244, 4, v0
    buffer_load_dwordx4 v[240:243], v244, s[52:55], s15 offen
    s_add_u32 s15, s15, 32768
    buffer_load_dwordx4 v[240:243], v244, s[52:55], s15 offen
    s_sub_u32 s6, s5, 28
    s_lshl2_add_u32 s6, s4, s6
    s_lshr_b32 s7, s6, 3
    s_and_b32 s8, s6, 7
    s_lshl4_add_u32 s9, s8, s7
    s_mul_i32 s9, s9, 10272
    v_lshl_add_u32 v2, s3, 6, v0
    v_lshlrev_b32 v3, 4, v2
    v_add_u32 v68, 8192, v3
    v_cmp_gt_u32 vcc, 130, v2
    v_mov_b32 v4, 0x7fffffff
    s_nop 0
    v_cndmask_b32 v68, v4, v68, vcc
    s_waitcnt lgkmcnt(0)
    s_mov_b32 s48, s18
    s_mov_b32 s49, s19
    s_mov_b32 s50, 1314816
    s_mov_b32 s51, 0x20000
    s_mov_b32 s52, s20
    s_mov_b32 s53, s21
    s_mov_b32 s54, 1314816
    s_mov_b32 s55, 0x20000
    s_cmp_ge_u32 s3, 3
    s_cbranch_scc1 L_W_l0
    s_add_u32 s10, s9, 0
    buffer_load_dwordx4 v[36:39], v68, s[48:51], s10 offen
    buffer_load_dwordx4 v[52:55], v68, s[52:55], s10 offen
    s_add_u32 s10, s9, 41088
    buffer_load_dwordx4 v[40:43], v68, s[48:51], s10 offen
    buffer_load_dwordx4 v[56:59], v68, s[52:55], s10 offen
    s_add_u32 s10, s9, 82176
    buffer_load_dwordx4 v[44:47], v68, s[48:51], s10 offen
    buffer_load_dwordx4 v[60:63], v68, s[52:55], s10 offen
    s_add_u32 s10, s9, 123264
    buffer_load_dwordx4 v[48:51], v68, s[48:51], s10 offen
    buffer_load_dwordx4 v[64:67], v68, s[52:55], s10 offen
L_W_l0:
    s_add_u32 s10, s9, 0
    buffer_load_dwordx4 v[4:7], v3, s[48:51], s10 offen
    buffer_load_dwordx4 v[20:23], v3, s[52:55], s10 offen
    s_add_u32 s10, s9, 41088
    buffer_load_dwordx4 v[8:11], v3, s[48:51], s10 offen
    buffer_load_dwordx4 v[24:27], v3, s[52:55], s10 offen
    s_add_u32 s10, s9, 82176
    buffer_load_dwordx4 v[12:15], v3, s[48:51], s10 offen
    buffer_load_dwordx4 v[28:31], v3, s[52:55], s10 offen
    s_add_u32 s10, s9, 123264
    buffer_load_dwordx4 v[16:19], v3, s[48:51], s10 offen
    buffer_load_dwordx4 v[32:35], v3, s[52:55], s10 offen
    s_waitcnt lgkmcnt(0)
    s_load_dword s68, s[46:47], 40960
    s_mov_b32 s56, s46
    s_mov_b32 s57, s47
    s_mov_b32 s58, 13336576
    s_mov_b32 s59, 0x20000
    s_mov_b32 s10, 0x05040100
    s_mov_b32 s11, 0x07060302
    s_mov_b32 s12, 13379961
    v_lshlrev_b32 v69, 3, v2
    v_add_u32 v69, 0, v69
    v_mul_hi_u32 v70, v69, s12
    v_mul_u32_u24 v71, 321, v70
    v_sub_u32 v71, v69, v71
    v_lshrrev_b32 v72, 3, v71
    v_xor_b32 v72, v72, v70
    v_and_b32 v72, 15, v72
    v_lshlrev_b32 v73, 8, v71
    v_lshl_add_u32 v73, v72, 4, v73
    v_lshlrev_b32 v69, 3, v2
    v_add_u32 v69, 1, v69
    v_mul_hi_u32 v70, v69, s12
    v_mul_u32_u24 v71, 321, v70
    v_sub_u32 v71, v69, v71
    v_lshrrev_b32 v72, 3, v71
    v_xor_b32 v72, v72, v70
    v_and_b32 v72, 15, v72
    v_lshlrev_b32 v74, 8, v71
    v_lshl_add_u32 v74, v72, 4, v74
    v_lshlrev_b32 v69, 3, v2
    v_add_u32 v69, 2, v69
    v_mul_hi_u32 v70, v69, s12
    v_mul_u32_u24 v71, 321, v70
    v_sub_u32 v71, v69, v71
    v_lshrrev_b32 v72, 3, v71
    v_xor_b32 v72, v72, v70
    v_and_b32 v72, 15, v72
    v_lshlrev_b32 v75, 8, v71
    v_lshl_add_u32 v75, v72, 4, v75
    v_lshlrev_b32 v69, 3, v2
    v_add_u32 v69, 3, v69
    v_mul_hi_u32 v70, v69, s12
    v_mul_u32_u24 v71, 321, v70
    v_sub_u32 v71, v69, v71
    v_lshrrev_b32 v72, 3, v71
    v_xor_b32 v72, v72, v70
    v_and_b32 v72, 15, v72
    v_lshlrev_b32 v76, 8, v71
    v_lshl_add_u32 v76, v72, 4, v76
    v_lshlrev_b32 v69, 3, v2
    v_add_u32 v69, 4, v69
    v_mul_hi_u32 v70, v69, s12
    v_mul_u32_u24 v71, 321, v70
    v_sub_u32 v71, v69, v71
    v_lshrrev_b32 v72, 3, v71
    v_xor_b32 v72, v72, v70
    v_and_b32 v72, 15, v72
    v_lshlrev_b32 v77, 8, v71
    v_lshl_add_u32 v77, v72, 4, v77
    v_lshlrev_b32 v69, 3, v2
    v_add_u32 v69, 5, v69
    v_mul_hi_u32 v70, v69, s12
    v_mul_u32_u24 v71, 321, v70
    v_sub_u32 v71, v69, v71
    v_lshrrev_b32 v72, 3, v71
    v_xor_b32 v72, v72, v70
    v_and_b32 v72, 15, v72
    v_lshlrev_b32 v78, 8, v71
    v_lshl_add_u32 v78, v72, 4, v78
    v_lshlrev_b32 v69, 3, v2
    v_add_u32 v69, 6, v69
    v_mul_hi_u32 v70, v69, s12
    v_mul_u32_u24 v71, 321, v70
    v_sub_u32 v71, v69, v71
    v_lshrrev_b32 v72, 3, v71
    v_xor_b32 v72, v72, v70
    v_and_b32 v72, 15, v72
    v_lshlrev_b32 v79, 8, v71
    v_lshl_add_u32 v79, v72, 4, v79
    v_lshlrev_b32 v69, 3, v2
    v_add_u32 v69, 7, v69
    v_mul_hi_u32 v70, v69, s12
    v_mul_u32_u24 v71, 321, v70
    v_sub_u32 v71, v69, v71
    v_lshrrev_b32 v72, 3, v71
    v_xor_b32 v72, v72, v70
    v_and_b32 v72, 15, v72
    v_lshlrev_b32 v80, 8, v71
    v_lshl_add_u32 v80, v72, 4, v80
    v_lshlrev_b32 v69, 3, v2
    v_add_u32 v69, 4096, v69
    v_mul_hi_u32 v70, v69, s12
    v_mul_u32_u24 v71, 321, v70
    v_sub_u32 v71, v69, v71
    v_lshrrev_b32 v72, 3, v71
    v_xor_b32 v72, v72, v70
    v_and_b32 v72, 15, v72
    v_lshlrev_b32 v81, 8, v71
    v_lshl_add_u32 v81, v72, 4, v81
    v_cmp_gt_u32 vcc, 16, v70
    v_mov_b32 v72, 82176
    s_nop 0
    v_cndmask_b32 v81, v72, v81, vcc
    v_lshlrev_b32 v69, 3, v2
    v_add_u32 v69, 4097, v69
    v_mul_hi_u32 v70, v69, s12
    v_mul_u32_u24 v71, 321, v70
    v_sub_u32 v71, v69, v71
    v_lshrrev_b32 v72, 3, v71
    v_xor_b32 v72, v72, v70
    v_and_b32 v72, 15, v72
    v_lshlrev_b32 v82, 8, v71
    v_lshl_add_u32 v82, v72, 4, v82
    v_cmp_gt_u32 vcc, 16, v70
    v_mov_b32 v72, 82176
    s_nop 0
    v_cndmask_b32 v82, v72, v82, vcc
    v_lshlrev_b32 v69, 3, v2
    v_add_u32 v69, 4098, v69
    v_mul_hi_u32 v70, v69, s12
    v_mul_u32_u24 v71, 321, v70
    v_sub_u32 v71, v69, v71
    v_lshrrev_b32 v72, 3, v71
    v_xor_b32 v72, v72, v70
    v_and_b32 v72, 15, v72
    v_lshlrev_b32 v83, 8, v71
    v_lshl_add_u32 v83, v72, 4, v83
    v_cmp_gt_u32 vcc, 16, v70
    v_mov_b32 v72, 82176
    s_nop 0
    v_cndmask_b32 v83, v72, v83, vcc
    v_lshlrev_b32 v69, 3, v2
    v_add_u32 v69, 4099, v69
    v_mul_hi_u32 v70, v69, s12
    v_mul_u32_u24 v71, 321, v70
    v_sub_u32 v71, v69, v71
    v_lshrrev_b32 v72, 3, v71
    v_xor_b32 v72, v72, v70
    v_and_b32 v72, 15, v72
    v_lshlrev_b32 v84, 8, v71
    v_lshl_add_u32 v84, v72, 4, v84
    v_cmp_gt_u32 vcc, 16, v70
    v_mov_b32 v72, 82176
    s_nop 0
    v_cndmask_b32 v84, v72, v84, vcc
    v_lshlrev_b32 v69, 3, v2
    v_add_u32 v69, 4100, v69
    v_mul_hi_u32 v70, v69, s12
    v_mul_u32_u24 v71, 321, v70
    v_sub_u32 v71, v69, v71
    v_lshrrev_b32 v72, 3, v71
    v_xor_b32 v72, v72, v70
    v_and_b32 v72, 15, v72
    v_lshlrev_b32 v85, 8, v71
    v_lshl_add_u32 v85, v72, 4, v85
    v_cmp_gt_u32 vcc, 16, v70
    v_mov_b32 v72, 82176
    s_nop 0
    v_cndmask_b32 v85, v72, v85, vcc
    v_lshlrev_b32 v69, 3, v2
    v_add_u32 v69, 4101, v69
    v_mul_hi_u32 v70, v69, s12
    v_mul_u32_u24 v71, 321, v70
    v_sub_u32 v71, v69, v71
    v_lshrrev_b32 v72, 3, v71
    v_xor_b32 v72, v72, v70
    v_and_b32 v72, 15, v72
    v_lshlrev_b32 v86, 8, v71
    v_lshl_add_u32 v86, v72, 4, v86
    v_cmp_gt_u32 vcc, 16, v70
    v_mov_b32 v72, 82176
    s_nop 0
    v_cndmask_b32 v86, v72, v86, vcc
    v_lshlrev_b32 v69, 3, v2
    v_add_u32 v69, 4102, v69
    v_mul_hi_u32 v70, v69, s12
    v_mul_u32_u24 v71, 321, v70
    v_sub_u32 v71, v69, v71
    v_lshrrev_b32 v72, 3, v71
    v_xor_b32 v72, v72, v70
    v_and_b32 v72, 15, v72
    v_lshlrev_b32 v87, 8, v71
    v_lshl_add_u32 v87, v72, 4, v87
    v_cmp_gt_u32 vcc, 16, v70
    v_mov_b32 v72, 82176
    s_nop 0
    v_cndmask_b32 v87, v72, v87, vcc
    v_lshlrev_b32 v69, 3, v2
    v_add_u32 v69, 4103, v69
    v_mul_hi_u32 v70, v69, s12
    v_mul_u32_u24 v71, 321, v70
    v_sub_u32 v71, v69, v71
    v_lshrrev_b32 v72, 3, v71
    v_xor_b32 v72, v72, v70
    v_and_b32 v72, 15, v72
    v_lshlrev_b32 v88, 8, v71
    v_lshl_add_u32 v88, v72, 4, v88
    v_cmp_gt_u32 vcc, 16, v70
    v_mov_b32 v72, 82176
    s_nop 0
    v_cndmask_b32 v88, v72, v88, vcc
    v_lshrrev_b32 v71, 4, v2
    v_and_b32 v70, 15, v2
    v_lshlrev_b32 v3, 13, v71
    v_lshl_add_u32 v3, v70, 4, v3
    s_lshl_b32 s9, s6, 8
    v_lshrrev_b32 v72, 3, v71
    v_add_u32 v69, 0, v72
    v_xor_b32 v69, v69, v70
    v_lshlrev_b32 v69, 4, v69
    v_lshl_add_u32 v100, v71, 8, v69
    v_add_u32 v69, 4, v72
    v_xor_b32 v69, v69, v70
    v_lshlrev_b32 v69, 4, v69
    v_lshl_add_u32 v101, v71, 8, v69
    v_add_u32 v69, 8, v72
    v_xor_b32 v69, v69, v70
    v_lshlrev_b32 v69, 4, v69
    v_lshl_add_u32 v102, v71, 8, v69
    v_add_u32 v69, 12, v72
    v_xor_b32 v69, v69, v70
    v_lshlrev_b32 v69, 4, v69
    v_lshl_add_u32 v103, v71, 8, v69
    s_add_u32 s48, s46, 2842624
    s_addc_u32 s49, s47, 0
    s_mov_b32 s50, 2629632
    s_mov_b32 s51, 0x20000
    v_mov_b32 v92, 94208
    v_mov_b32 v93, 0
    ds_write_b32 v92, v93
    s_waitcnt lgkmcnt(0)
    s_add_u32 s68, s68, 1
    s_cmp_ge_u32 s3, 3
    s_cbranch_scc1 L_W2
    s_waitcnt vmcnt(8)
    v_perm_b32 v92, v52, v36, s10
    v_perm_b32 v93, v56, v40, s10
    v_perm_b32 v94, v60, v44, s10
    v_perm_b32 v95, v64, v48, s10
    ds_write_b128 v81, v[92:95]
    v_perm_b32 v96, v52, v36, s11
    v_perm_b32 v97, v56, v40, s11
    v_perm_b32 v98, v60, v44, s11
    v_perm_b32 v99, v64, v48, s11
    ds_write_b128 v82, v[96:99]
    v_perm_b32 v92, v53, v37, s10
    v_perm_b32 v93, v57, v41, s10
    v_perm_b32 v94, v61, v45, s10
    v_perm_b32 v95, v65, v49, s10
    ds_write_b128 v83, v[92:95]
    v_perm_b32 v96, v53, v37, s11
    v_perm_b32 v97, v57, v41, s11
    v_perm_b32 v98, v61, v45, s11
    v_perm_b32 v99, v65, v49, s11
    ds_write_b128 v84, v[96:99]
    v_perm_b32 v92, v54, v38, s10
    v_perm_b32 v93, v58, v42, s10
    v_perm_b32 v94, v62, v46, s10
    v_perm_b32 v95, v66, v50, s10
    ds_write_b128 v85, v[92:95]
    v_perm_b32 v96, v54, v38, s11
    v_perm_b32 v97, v58, v42, s11
    v_perm_b32 v98, v62, v46, s11
    v_perm_b32 v99, v66, v50, s11
    ds_write_b128 v86, v[96:99]
    v_perm_b32 v92, v55, v39, s10
    v_perm_b32 v93, v59, v43, s10
    v_perm_b32 v94, v63, v47, s10
    v_perm_b32 v95, v67, v51, s10
    ds_write_b128 v87, v[92:95]
    v_perm_b32 v96, v55, v39, s11
    v_perm_b32 v97, v59, v43, s11
    v_perm_b32 v98, v63, v47, s11
    v_perm_b32 v99, v67, v51, s11
    ds_write_b128 v88, v[96:99]
L_W2:
    s_waitcnt vmcnt(0)
    v_perm_b32 v92, v20, v4, s10
    v_perm_b32 v93, v24, v8, s10
    v_perm_b32 v94, v28, v12, s10
    v_perm_b32 v95, v32, v16, s10
    ds_write_b128 v73, v[92:95]
    v_perm_b32 v96, v20, v4, s11
    v_perm_b32 v97, v24, v8, s11
    v_perm_b32 v98, v28, v12, s11
    v_perm_b32 v99, v32, v16, s11
    ds_write_b128 v74, v[96:99]
    v_perm_b32 v92, v21, v5, s10
    v_perm_b32 v93, v25, v9, s10
    v_perm_b32 v94, v29, v13, s10
    v_perm_b32 v95, v33, v17, s10
    ds_write_b128 v75, v[92:95]
    v_perm_b32 v96, v21, v5, s11
    v_perm_b32 v97, v25, v9, s11
    v_perm_b32 v98, v29, v13, s11
    v_perm_b32 v99, v33, v17, s11
    ds_write_b128 v76, v[96:99]
    v_perm_b32 v92, v22, v6, s10
    v_perm_b32 v93, v26, v10, s10
    v_perm_b32 v94, v30, v14, s10
    v_perm_b32 v95, v34, v18, s10
    ds_write_b128 v77, v[92:95]
    v_perm_b32 v96, v22, v6, s11
    v_perm_b32 v97, v26, v10, s11
    v_perm_b32 v98, v30, v14, s11
    v_perm_b32 v99, v34, v18, s11
    ds_write_b128 v78, v[96:99]
    v_perm_b32 v92, v23, v7, s10
    v_perm_b32 v93, v27, v11, s10
    v_perm_b32 v94, v31, v15, s10
    v_perm_b32 v95, v35, v19, s10
    ds_write_b128 v79, v[92:95]
    v_perm_b32 v96, v23, v7, s11
    v_perm_b32 v97, v27, v11, s11
    v_perm_b32 v98, v31, v15, s11
    v_perm_b32 v99, v35, v19, s11
    ds_write_b128 v80, v[96:99]
    s_waitcnt vmcnt(0) lgkmcnt(0)
    s_barrier
    s_cmp_lg_u32 s3, 0
    s_cbranch_scc1 L_xp6
    s_getreg_b32 s15, hwreg(HW_REG_XCC_ID, 0, 4)
    v_mov_b32 v92, s68
    v_mov_b32 v93, s15
    v_mov_b32 v94, 0
    s_lshl_b32 s15, s4, 5
    s_add_u32 s15, s15, s5
    s_lshl_b32 s15, s15, 3
    s_add_u32 s15, s15, 36864
    buffer_store_dwordx2 v[92:93], v94, s[56:59], s15 offen sc1
L_xp6:
    ds_read_b128 v[4:7], v100 offset:0
    ds_read_b128 v[8:11], v101 offset:8192
    ds_read_b128 v[12:15], v102 offset:16384
    ds_read_b128 v[16:19], v103 offset:24576
    ds_read_b128 v[20:23], v100 offset:32768
    ds_read_b128 v[24:27], v101 offset:40960
    ds_read_b128 v[28:31], v102 offset:49152
    ds_read_b128 v[32:35], v103 offset:57344
    v_add_u32 v100, 65536, v100
    v_add_u32 v101, 65536, v101
    v_add_u32 v102, 65536, v102
    v_add_u32 v103, 65536, v103
    ds_read_b128 v[36:39], v100 offset:0
    ds_read_b128 v[40:43], v101 offset:8192
    ds_read_b128 v[44:47], v102 offset:16384
    s_waitcnt lgkmcnt(10)
    buffer_store_dwordx4 v[4:7], v3, s[48:51], s9 offen sc1
    s_add_u32 s9, s9, 262144
    s_waitcnt lgkmcnt(9)
    buffer_store_dwordx4 v[8:11], v3, s[48:51], s9 offen sc1
    s_add_u32 s9, s9, 262144
    s_waitcnt lgkmcnt(8)
    buffer_store_dwordx4 v[12:15], v3, s[48:51], s9 offen sc1
    s_add_u32 s9, s9, 262144
    s_waitcnt lgkmcnt(7)
    buffer_store_dwordx4 v[16:19], v3, s[48:51], s9 offen sc1
    s_add_u32 s9, s9, 262144
    s_waitcnt lgkmcnt(6)
    buffer_store_dwordx4 v[20:23], v3, s[48:51], s9 offen sc1
    s_add_u32 s9, s9, 262144
    s_waitcnt lgkmcnt(5)
    buffer_store_dwordx4 v[24:27], v3, s[48:51], s9 offen sc1
    s_add_u32 s9, s9, 262144
    s_waitcnt lgkmcnt(4)
    buffer_store_dwordx4 v[28:31], v3, s[48:51], s9 offen sc1
    s_add_u32 s9, s9, 262144
    s_waitcnt lgkmcnt(3)
    buffer_store_dwordx4 v[32:35], v3, s[48:51], s9 offen sc1
    s_add_u32 s9, s9, 262144
    s_waitcnt lgkmcnt(2)
    buffer_store_dwordx4 v[36:39], v3, s[48:51], s9 offen sc1
    s_add_u32 s9, s9, 262144
    s_waitcnt lgkmcnt(1)
    buffer_store_dwordx4 v[40:43], v3, s[48:51], s9 offen sc1
    s_add_u32 s9, s9, 262144
    s_waitcnt lgkmcnt(0)
    buffer_store_dwordx4 v[44:47], v3, s[48:51], s9 offen sc1
    s_add_u32 s9, s9, 262144
    s_lshr_b32 s6, s5, 3
    s_mul_i32 s67, s6, 5
    s_lshr_b32 s67, s67, 1
    s_lshl2_add_u32 s65, s4, s6
    s_and_b32 s66, s5, 3
    s_bfe_u32 s8, s5, 0x10002
    s_mul_i32 s8, s8, 80
    s_add_u32 s9, s8, 64
    s_lshl4_add_u32 s60, s66, s8
    s_sub_u32 s61, 304, s60
    s_add_u32 s62, 320, s60
    s_sub_u32 s63, 624, s60
    s_sub_u32 s11, 304, s9
    s_bitcmp1_b32 s66, 0
    s_cselect_b32 s64, s11, s9
    s_bitcmp1_b32 s66, 1
    s_cselect_b32 s10, 320, 0
    s_add_u32 s64, s64, s10
    s_bitcmp0_b32 s3, 1
    s_cselect_b32 s72, s32, s34
    s_cselect_b32 s73, s33, s35
    s_mov_b32 s74, 819200
    s_mov_b32 s75, 0x20000
    s_cmp_ge_u32 s3, 4
    s_cbranch_scc1 L_W_c1
    s_and_b32 s10, s3, 3
    v_and_b32 v160, 15, v0
    v_lshrrev_b32 v161, 4, v0
    s_lshl_b32 s11, s10, 14
    s_add_u32 s11, s11, 98304
    v_lshl_add_u32 v162, v0, 4, s11
    v_cvt_f32_u32 v164, v161
    v_lshl_add_u32 v163, s10, 4, v160
    v_cvt_f32_u32 v163, v163
    v_mul_f32 v166, v163, v164
    v_mul_f32 v166, 0x3e000000, v166
    v_fmamk_f32 v168, v163, 0x00000000, v166
    v_fmamk_f32 v169, v163, 0x3c800000, v166
    v_fmamk_f32 v170, v163, 0x3d000000, v166
    v_fmamk_f32 v171, v163, 0x3d400000, v166
    v_fmamk_f32 v172, v163, 0x3d800000, v166
    v_fmamk_f32 v173, v163, 0x3da00000, v166
    v_fmamk_f32 v174, v163, 0x3dc00000, v166
    v_fmamk_f32 v175, v163, 0x3de00000, v166
    v_sin_f32 v176, v168
    v_sin_f32 v177, v169
    v_sin_f32 v178, v170
    v_sin_f32 v179, v171
    v_sin_f32 v180, v172
    v_sin_f32 v181, v173
    v_sin_f32 v182, v174
    v_sin_f32 v183, v175
    v_cos_f32 v168, v168
    v_cos_f32 v169, v169
    v_cos_f32 v170, v170
    v_cos_f32 v171, v171
    v_cos_f32 v172, v172
    v_cos_f32 v173, v173
    v_cos_f32 v174, v174
    v_cos_f32 v175, v175
    v_cvt_pk_bf16_f32 v188, v176, v177
    v_cvt_pk_bf16_f32 v189, v178, v179
    v_cvt_pk_bf16_f32 v190, v180, v181
    v_cvt_pk_bf16_f32 v191, v182, v183
    v_cvt_pk_bf16_f32 v184, v168, v169
    v_cvt_pk_bf16_f32 v185, v170, v171
    v_cvt_pk_bf16_f32 v186, v172, v173
    v_cvt_pk_bf16_f32 v187, v174, v175
    ds_write_b128 v162, v[184:187] offset:0
    ds_write_b128 v162, v[188:191] offset:2048
    v_mul_f32 v166, v163, v164
    v_mul_f32 v166, 0x3e000000, v166
    v_fmamk_f32 v168, v163, 0x3f000000, v166
    v_fmamk_f32 v169, v163, 0x3f040000, v166
    v_fmamk_f32 v170, v163, 0x3f080000, v166
    v_fmamk_f32 v171, v163, 0x3f0c0000, v166
    v_fmamk_f32 v172, v163, 0x3f100000, v166
    v_fmamk_f32 v173, v163, 0x3f140000, v166
    v_fmamk_f32 v174, v163, 0x3f180000, v166
    v_fmamk_f32 v175, v163, 0x3f1c0000, v166
    v_sin_f32 v176, v168
    v_sin_f32 v177, v169
    v_sin_f32 v178, v170
    v_sin_f32 v179, v171
    v_sin_f32 v180, v172
    v_sin_f32 v181, v173
    v_sin_f32 v182, v174
    v_sin_f32 v183, v175
    v_cos_f32 v168, v168
    v_cos_f32 v169, v169
    v_cos_f32 v170, v170
    v_cos_f32 v171, v171
    v_cos_f32 v172, v172
    v_cos_f32 v173, v173
    v_cos_f32 v174, v174
    v_cos_f32 v175, v175
    v_cvt_pk_bf16_f32 v196, v176, v177
    v_cvt_pk_bf16_f32 v197, v178, v179
    v_cvt_pk_bf16_f32 v198, v180, v181
    v_cvt_pk_bf16_f32 v199, v182, v183
    v_cvt_pk_bf16_f32 v192, v168, v169
    v_cvt_pk_bf16_f32 v193, v170, v171
    v_cvt_pk_bf16_f32 v194, v172, v173
    v_cvt_pk_bf16_f32 v195, v174, v175
    ds_write_b128 v162, v[192:195] offset:1024
    ds_write_b128 v162, v[196:199] offset:3072
    v_mul_f32 v166, v163, v164
    v_mul_f32 v166, 0x3b000000, v166
    v_fmamk_f32 v168, v163, 0x00000000, v166
    v_fmamk_f32 v169, v163, 0x3a000000, v166
    v_fmamk_f32 v170, v163, 0x3a800000, v166
    v_fmamk_f32 v171, v163, 0x3ac00000, v166
    v_fmamk_f32 v172, v163, 0x3c000000, v166
    v_fmamk_f32 v173, v163, 0x3c080000, v166
    v_fmamk_f32 v174, v163, 0x3c100000, v166
    v_fmamk_f32 v175, v163, 0x3c180000, v166
    v_sin_f32 v176, v168
    v_sin_f32 v177, v169
    v_sin_f32 v178, v170
    v_sin_f32 v179, v171
    v_sin_f32 v180, v172
    v_sin_f32 v181, v173
    v_sin_f32 v182, v174
    v_sin_f32 v183, v175
    v_cos_f32 v168, v168
    v_cos_f32 v169, v169
    v_cos_f32 v170, v170
    v_cos_f32 v171, v171
    v_cos_f32 v172, v172
    v_cos_f32 v173, v173
    v_cos_f32 v174, v174
    v_cos_f32 v175, v175
    ds_write_b128 v162, v[168:171] offset:4096
    ds_write_b128 v162, v[176:179] offset:6144
    ds_write_b128 v162, v[172:175] offset:5120
    ds_write_b128 v162, v[180:183] offset:7168
    s_branch L_W_c2
L_W_c1:
    s_and_b32 s10, s3, 3
    v_and_b32 v160, 15, v0
    v_lshrrev_b32 v161, 4, v0
    s_lshl_b32 s11, s10, 14
    s_add_u32 s11, s11, 106496
    v_lshl_add_u32 v162, v0, 4, s11
    v_cvt_f32_u32 v164, v161
    v_cvt_f32_u32 v165, v160
    v_add_f32 v167, 0x41800000, v165
    v_mul_f32 v166, v165, v164
    v_mul_f32 v166, 0x3e000000, v166
    v_fmamk_f32 v168, v165, 0x00000000, v166
    v_fmamk_f32 v169, v165, 0x3d000000, v166
    v_fmamk_f32 v170, v165, 0x3d800000, v166
    v_fmamk_f32 v171, v165, 0x3dc00000, v166
    v_fmamk_f32 v172, v165, 0x3f000000, v166
    v_fmamk_f32 v173, v165, 0x3f080000, v166
    v_fmamk_f32 v174, v165, 0x3f100000, v166
    v_fmamk_f32 v175, v165, 0x3f180000, v166
    v_sin_f32 v176, v168
    v_sin_f32 v177, v169
    v_sin_f32 v178, v170
    v_sin_f32 v179, v171
    v_sin_f32 v180, v172
    v_sin_f32 v181, v173
    v_sin_f32 v182, v174
    v_sin_f32 v183, v175
    v_cos_f32 v168, v168
    v_cos_f32 v169, v169
    v_cos_f32 v170, v170
    v_cos_f32 v171, v171
    v_cos_f32 v172, v172
    v_cos_f32 v173, v173
    v_cos_f32 v174, v174
    v_cos_f32 v175, v175
    v_cvt_pk_bf16_f32 v188, v176, v177
    v_cvt_pk_bf16_f32 v189, v178, v179
    v_cvt_pk_bf16_f32 v190, v180, v181
    v_cvt_pk_bf16_f32 v191, v182, v183
    v_cvt_pk_bf16_f32 v184, v168, v169
    v_cvt_pk_bf16_f32 v185, v170, v171
    v_cvt_pk_bf16_f32 v186, v172, v173
    v_cvt_pk_bf16_f32 v187, v174, v175
    ds_write_b128 v162, v[184:187] offset:0
    ds_write_b128 v162, v[188:191] offset:2048
    v_mul_f32 v166, v167, v164
    v_mul_f32 v166, 0x3e000000, v166
    v_fmamk_f32 v168, v167, 0x00000000, v166
    v_fmamk_f32 v169, v167, 0x3d000000, v166
    v_fmamk_f32 v170, v167, 0x3d800000, v166
    v_fmamk_f32 v171, v167, 0x3dc00000, v166
    v_fmamk_f32 v172, v167, 0x3f000000, v166
    v_fmamk_f32 v173, v167, 0x3f080000, v166
    v_fmamk_f32 v174, v167, 0x3f100000, v166
    v_fmamk_f32 v175, v167, 0x3f180000, v166
    v_sin_f32 v176, v168
    v_sin_f32 v177, v169
    v_sin_f32 v178, v170
    v_sin_f32 v179, v171
    v_sin_f32 v180, v172
    v_sin_f32 v181, v173
    v_sin_f32 v182, v174
    v_sin_f32 v183, v175
    v_cos_f32 v168, v168
    v_cos_f32 v169, v169
    v_cos_f32 v170, v170
    v_cos_f32 v171, v171
    v_cos_f32 v172, v172
    v_cos_f32 v173, v173
    v_cos_f32 v174, v174
    v_cos_f32 v175, v175
    v_cvt_pk_bf16_f32 v196, v176, v177
    v_cvt_pk_bf16_f32 v197, v178, v179
    v_cvt_pk_bf16_f32 v198, v180, v181
    v_cvt_pk_bf16_f32 v199, v182, v183
    v_cvt_pk_bf16_f32 v192, v168, v169
    v_cvt_pk_bf16_f32 v193, v170, v171
    v_cvt_pk_bf16_f32 v194, v172, v173
    v_cvt_pk_bf16_f32 v195, v174, v175
    ds_write_b128 v162, v[192:195] offset:1024
    ds_write_b128 v162, v[196:199] offset:3072
    v_lshlrev_b32 v166, 2, v161
    v_lshl_add_u32 v166, s10, 4, v166
    v_cvt_f32_u32 v166, v166
    v_mul_f32 v166, 0x3a000000, v166
    v_mul_f32 v168, v165, v166
    v_fmamk_f32 v169, v165, 0x3a000000, v168
    v_fmamk_f32 v170, v165, 0x3a800000, v168
    v_fmamk_f32 v171, v165, 0x3ac00000, v168
    v_mul_f32 v172, v167, v166
    v_fmamk_f32 v173, v167, 0x3a000000, v172
    v_fmamk_f32 v174, v167, 0x3a800000, v172
    v_fmamk_f32 v175, v167, 0x3ac00000, v172
    v_sin_f32 v176, v168
    v_sin_f32 v177, v169
    v_sin_f32 v178, v170
    v_sin_f32 v179, v171
    v_sin_f32 v180, v172
    v_sin_f32 v181, v173
    v_sin_f32 v182, v174
    v_sin_f32 v183, v175
    v_cos_f32 v168, v168
    v_cos_f32 v169, v169
    v_cos_f32 v170, v170
    v_cos_f32 v171, v171
    v_cos_f32 v172, v172
    v_cos_f32 v173, v173
    v_cos_f32 v174, v174
    v_cos_f32 v175, v175
    v_mul_f32 v176, 0x35cccccd, v176
    v_mul_f32 v177, 0x35cccccd, v177
    v_mul_f32 v178, 0x35cccccd, v178
    v_mul_f32 v179, 0x35cccccd, v179
    v_mul_f32 v180, 0x35cccccd, v180
    v_mul_f32 v181, 0x35cccccd, v181
    v_mul_f32 v182, 0x35cccccd, v182
    v_mul_f32 v183, 0x35cccccd, v183
    v_mul_f32 v168, 0x35cccccd, v168
    v_mul_f32 v169, 0x35cccccd, v169
    v_mul_f32 v170, 0x35cccccd, v170
    v_mul_f32 v171, 0x35cccccd, v171
    v_mul_f32 v172, 0x35cccccd, v172
    v_mul_f32 v173, 0x35cccccd, v173
    v_mul_f32 v174, 0x35cccccd, v174
    v_mul_f32 v175, 0x35cccccd, v175
    ds_write_b128 v162, v[168:171] offset:4096
    ds_write_b128 v162, v[176:179] offset:6144
    ds_write_b128 v162, v[172:175] offset:5120
    ds_write_b128 v162, v[180:183] offset:7168
L_W_c2:
    s_sub_u32 s6, 31, s5
    s_lshl3_add_u32 s6, s6, s4
    v_mov_b32 v92, 94208
    v_mov_b32 v93, 1
    s_mov_b64 exec, 1
    s_waitcnt vmcnt(0)
    ds_add_rtn_u32 v93, v92, v93
    s_waitcnt lgkmcnt(0)
    v_readfirstlane_b32 s10, v93
    s_mov_b64 exec, -1
    s_cmp_lg_u32 s10, 7
    s_cbranch_scc1 L_rf7
    v_mov_b32 v92, s68
    s_lshl_b32 s15, s6, 7
    v_mov_b32 v93, 0
    buffer_store_dword v92, v93, s[56:59], s15 offen sc1
L_rf7:
    s_barrier
L_F:
    s_sub_u32 s6, 31, s5
    s_lshl3_add_u32 s6, s6, s4
    s_lshr_b32 s7, s3, 2
    s_and_b32 s14, s3, 3
    s_lshl1_add_u32 s48, s6, s7
    s_lshl_b32 s7, s7, 14
    s_cmp_ge_u32 s48, 160
    s_cselect_b32 s10, 0, s48
    s_lshl_b32 s49, s10, 14
    s_lshl_b32 s11, s14, 12
    s_add_u32 s49, s49, s11
    s_add_u32 s49, s49, 221184
    s_add_u32 s50, s7, s11
    s_add_u32 s50, s50, 122880
    s_lshl_b32 s51, s10, 8
    s_mul_i32 s11, s14, 655360
    s_add_u32 s51, s51, s11
    s_add_u32 s51, s51, 5472256
    s_add_u32 s52, s51, 40960
    s_mov_b32 s53, s52
    s_lshl_b32 s11, s10, 2
    s_sub_u32 s12, s11, 319
    s_cmp_ge_u32 s10, 80
    s_cselect_b32 s11, s12, s11
    s_cmp_eq_u32 s48, 160
    s_cselect_b32 s11, 320, s11
    s_cselect_b32 s54, 8192, 0
    s_lshl2_add_u32 s8, s11, s14
    s_lshl_b32 s8, s8, 11
    s_add_u32 s8, s8, 2842624
    s_add_u32 s9, s8, 16384
    s_cmp_ge_u32 s48, 160
    s_cselect_b32 s9, 2130706432, s9
    s_cselect_b32 s51, 2130706432, s51
    s_cmp_eq_u32 s10, 0
    s_cselect_b32 s52, 2130706432, s52
    s_cmp_gt_u32 s48, 160
    s_cselect_b32 s8, 2130706432, s8
    s_cselect_b32 s49, 2130706432, s49
    s_cselect_b32 s55, 1, s10
    v_and_b32 v2, 15, v0
    v_lshrrev_b32 v3, 4, v0
    v_lshlrev_b32 v4, 4, v0
    s_cmp_ge_u32 s5, 28
    s_cselect_b32 s10, 98304, 0
    s_lshl_b32 s11, s14, 14
    s_add_u32 s10, s10, s11
    v_add_u32 v88, s10, v4
    s_and_b32 s10, s3, 3
    v_lshrrev_b32 v8, 3, v0
    v_mul_u32_u24 v8, 1280, v8
    v_lshrrev_b32 v9, 4, v0
    v_and_b32 v10, 7, v0
    v_xor_b32 v10, v10, v9
    s_and_b32 s11, s10, 1
    s_lshl_b32 s12, s11, 2
    v_xor_b32 v10, s12, v10
    v_xor_b32 v11, 4, v10
    v_lshl_add_u32 v10, v10, 4, v8
    v_lshl_add_u32 v11, v11, 4, v8
    s_cmp_eq_u32 s11, 0
    s_cselect_b32 s12, s60, s62
    s_cselect_b32 s13, 0, 8
    v_mov_b32 v12, s12
    v_add_u32 v12, s13, v12
    v_mul_u32_u24 v12, 1280, v12
    v_add_u32 v250, v12, v10
    s_cselect_b32 s12, s60, s63
    s_cselect_b32 s13, 8, 0
    v_mov_b32 v12, s12
    v_add_u32 v12, s13, v12
    v_mul_u32_u24 v12, 1280, v12
    v_add_u32 v251, v12, v11
    s_cselect_b32 s12, s61, s63
    s_cselect_b32 s13, 0, 8
    v_mov_b32 v12, s12
    v_add_u32 v12, s13, v12
    v_mul_u32_u24 v12, 1280, v12
    v_add_u32 v252, v12, v10
    s_cselect_b32 s12, s61, s64
    s_cselect_b32 s13, 8, 0
    v_mov_b32 v12, s12
    v_add_u32 v12, s13, v12
    v_mul_u32_u24 v12, 1280, v12
    v_add_u32 v253, v12, v11
    s_cselect_b32 s12, s62, s64
    s_cselect_b32 s13, 0, 8
    v_mov_b32 v12, s12
    v_add_u32 v12, s13, v12
    v_mul_u32_u24 v12, 1280, v12
    v_add_u32 v254, v12, v10
    s_mul_i32 s70, s10, 5120
    s_lshl_b32 s69, s67, 7
    v_lshrrev_b32 v5, 1, v2
    v_lshrrev_b32 v243, 1, v3
    v_lshl_add_u32 v243, s14, 1, v243
    v_xor_b32 v243, v243, v5
    v_lshlrev_b32 v243, 4, v243
    v_lshl_add_u32 v243, v2, 7, v243
    v_and_b32 v242, 1, v3
    v_lshl_add_u32 v243, v242, 3, v243
    v_xor_b32 v244, v3, v5
    v_lshlrev_b32 v244, 4, v244
    v_lshl_add_u32 v244, v2, 7, v244
    s_add_u32 s10, s7, 81920
    v_add_u32 v243, s10, v243
    v_add_u32 v244, s10, v244
    v_xor_b32 v245, 64, v244
    v_mul_u32_u24 v246, 163840, v3
    v_lshl_add_u32 v246, v2, 4, v246
    v_add_u32 v247, 81920, v246
    v_lshlrev_b32 v5, 10, v3
    v_lshl_add_u32 v5, v2, 4, v5
    s_add_u32 s10, s7, 122880
    s_add_u32 s11, s10, s54
    s_add_u32 s10, s10, 8192
    v_add_u32 v240, s11, v5
    v_add_u32 v241, s10, v5
    ds_read_b128 v[104:107], v88 offset:0
    ds_read_b128 v[108:111], v88 offset:1024
    ds_read_b128 v[112:115], v88 offset:2048
    ds_read_b128 v[116:119], v88 offset:3072
    ds_read_b128 v[152:155], v88 offset:4096
    ds_read_b128 v[156:159], v88 offset:5120
    ds_read_b128 v[160:163], v88 offset:6144
    ds_read_b128 v[164:167], v88 offset:7168
    ds_read_b128 v[128:131], v88 offset:8192
    s_waitcnt lgkmcnt(4)
    ds_read_b128 v[132:135], v88 offset:9216
    ds_read_b128 v[136:139], v88 offset:10240
    ds_read_b128 v[140:143], v88 offset:11264
    ds_read_b128 v[168:171], v88 offset:12288
    ds_read_b128 v[172:175], v88 offset:13312
    ds_read_b128 v[176:179], v88 offset:14336
    ds_read_b128 v[180:183], v88 offset:15360
    s_waitcnt lgkmcnt(0)
    s_mov_b32 s7, 0x80008000
    v_xor_b32 v120, s7, v112
    v_xor_b32 v121, s7, v113
    v_xor_b32 v122, s7, v114
    v_xor_b32 v123, s7, v115
    v_xor_b32 v124, s7, v116
    v_xor_b32 v125, s7, v117
    v_xor_b32 v126, s7, v118
    v_xor_b32 v127, s7, v119
    v_xor_b32 v144, s7, v136
    v_xor_b32 v145, s7, v137
    v_xor_b32 v146, s7, v138
    v_xor_b32 v147, s7, v139
    v_xor_b32 v148, s7, v140
    v_xor_b32 v149, s7, v141
    v_xor_b32 v150, s7, v142
    v_xor_b32 v151, s7, v143
    s_mov_b32 s7, 0xffff0000
    s_cmp_lg_u32 s3, 0
    s_cbranch_scc1 L_F_go
    v_lshlrev_b32 v232, 7, v0
    s_mov_b32 s15, 0x20000
    s_mov_b32 s1, 4096
L_poll8:
    buffer_load_dword v234, v232, s[56:59], s1 offen sc1
    s_waitcnt vmcnt(0)
    v_xor_b32 v234, s68, v234
    v_cmp_ne_u32 vcc, 0, v234
    s_cbranch_vccz L_poll8_ok
    s_sleep 2
    s_sub_u32 s15, s15, 1
    s_cbranch_scc0 L_poll8
L_poll8_ok:
L_F_go:
    s_mov_b32 m0, s50
    s_barrier
    buffer_load_dwordx4 v4, s[56:59], s49 offen offset:0 sc1 lds
    buffer_load_dwordx4 v4, s[56:59], s49 offen offset:1024 sc1 lds
    buffer_load_dwordx4 v4, s[56:59], s49 offen offset:2048 sc1 lds
    buffer_load_dwordx4 v4, s[56:59], s49 offen offset:3072 sc1 lds
    v_mov_b32 v184, 0
    v_mov_b32 v185, 0
    v_mov_b32 v186, 0
    v_mov_b32 v187, 0
    v_mov_b32 v188, 159296
    ds_write_b128 v188, v[184:187] offset:0
    ds_write_b128 v188, v[184:187] offset:144
    ds_write_b128 v188, v[184:187] offset:288
    s_cmp_lg_u32 s3, 4
    s_cbranch_scc1 L_F_go2
    v_and_b32 v232, 31, v0
    v_lshlrev_b32 v232, 7, v232
    s_mov_b32 s15, 0x20000
    s_mov_b32 s1, 0
L_poll9:
    buffer_load_dword v234, v232, s[56:59], s1 offen sc1
    s_waitcnt vmcnt(0)
    v_xor_b32 v234, s68, v234
    v_cmp_ne_u32 vcc, 0, v234
    s_cbranch_vccz L_poll9_ok
    s_sleep 2
    s_sub_u32 s15, s15, 1
    s_cbranch_scc0 L_poll9
L_poll9_ok:
L_F_go2:
    s_waitcnt vmcnt(0) lgkmcnt(0)
    s_barrier
    buffer_load_dwordx4 v[72:75], v4, s[56:59], s8 offen offset:0 sc1
    buffer_load_dwordx4 v[76:79], v4, s[56:59], s8 offen offset:1024 sc1
    buffer_load_dwordx4 v[80:83], v4, s[56:59], s9 offen offset:0 sc1
    buffer_load_dwordx4 v[84:87], v4, s[56:59], s9 offen offset:1024 sc1
    ds_read_b128 v[8:11], v240 offset:0
    ds_read_b128 v[40:43], v240 offset:512
    ds_read_b128 v[16:19], v240 offset:256
    ds_read_b128 v[48:51], v240 offset:768
    ds_read_b128 v[24:27], v241 offset:0
    ds_read_b128 v[56:59], v241 offset:512
    ds_read_b128 v[32:35], v241 offset:256
    ds_read_b128 v[64:67], v241 offset:768
    ds_read_b128 v[12:15], v240 offset:4096
    ds_read_b128 v[44:47], v240 offset:4608
    ds_read_b128 v[20:23], v240 offset:4352
    ds_read_b128 v[52:55], v240 offset:4864
    s_waitcnt lgkmcnt(8)
    ds_read_b128 v[28:31], v241 offset:4096
    ds_read_b128 v[60:63], v241 offset:4608
    ds_read_b128 v[36:39], v241 offset:4352
    ds_read_b128 v[68:71], v241 offset:4864
    s_waitcnt lgkmcnt(12)
    v_swap_b32 v10, v40
    v_swap_b32 v11, v41
    s_waitcnt lgkmcnt(12)
    v_swap_b32 v18, v48
    v_swap_b32 v19, v49
    s_waitcnt lgkmcnt(10)
    v_swap_b32 v26, v56
    v_swap_b32 v27, v57
    s_waitcnt lgkmcnt(8)
    v_swap_b32 v34, v64
    v_swap_b32 v35, v65
    s_waitcnt lgkmcnt(6)
    v_swap_b32 v14, v44
    v_swap_b32 v15, v45
    s_waitcnt lgkmcnt(4)
    v_swap_b32 v22, v52
    v_swap_b32 v23, v53
    s_waitcnt lgkmcnt(2)
    v_swap_b32 v30, v60
    v_swap_b32 v31, v61
    s_waitcnt lgkmcnt(0)
    v_swap_b32 v38, v68
    v_swap_b32 v39, v69
    s_cmp_lg_u32 s55, 0
    s_cbranch_scc1 L_F_ns1
    v_mov_b32 v24, 0
    v_mov_b32 v25, 0
    v_mov_b32 v26, 0
    v_mov_b32 v27, 0
    v_mov_b32 v28, 0
    v_mov_b32 v29, 0
    v_mov_b32 v30, 0
    v_mov_b32 v31, 0
    v_mov_b32 v32, 0
    v_mov_b32 v33, 0
    v_mov_b32 v34, 0
    v_mov_b32 v35, 0
    v_mov_b32 v36, 0
    v_mov_b32 v37, 0
    v_mov_b32 v38, 0
    v_mov_b32 v39, 0
L_F_ns1:
    v_mfma_f32_16x16x32_bf16 v[184:187], v[8:11], v[104:107], 0
    v_mfma_f32_16x16x32_bf16 v[192:195], v[24:27], v[104:107], 0
    v_mfma_f32_16x16x32_bf16 v[188:191], v[16:19], v[104:107], 0
    v_mfma_f32_16x16x32_bf16 v[196:199], v[32:35], v[104:107], 0
    v_mfma_f32_16x16x32_bf16 v[184:187], v[24:27], v[112:115], v[184:187]
    v_mfma_f32_16x16x32_bf16 v[192:195], v[8:11], v[120:123], v[192:195]
    v_mfma_f32_16x16x32_bf16 v[188:191], v[32:35], v[112:115], v[188:191]
    v_mfma_f32_16x16x32_bf16 v[196:199], v[16:19], v[120:123], v[196:199]
    v_mfma_f32_16x16x32_bf16 v[184:187], v[12:15], v[108:111], v[184:187]
    v_mfma_f32_16x16x32_bf16 v[192:195], v[28:31], v[108:111], v[192:195]
    v_mfma_f32_16x16x32_bf16 v[188:191], v[20:23], v[108:111], v[188:191]
    v_mfma_f32_16x16x32_bf16 v[196:199], v[36:39], v[108:111], v[196:199]
    v_mfma_f32_16x16x32_bf16 v[184:187], v[28:31], v[116:119], v[184:187]
    v_mfma_f32_16x16x32_bf16 v[192:195], v[12:15], v[124:127], v[192:195]
    v_mfma_f32_16x16x32_bf16 v[188:191], v[36:39], v[116:119], v[188:191]
    v_mfma_f32_16x16x32_bf16 v[196:199], v[20:23], v[124:127], v[196:199]
    v_mfma_f32_16x16x32_bf16 v[200:203], v[40:43], v[104:107], 0
    v_mfma_f32_16x16x32_bf16 v[208:211], v[56:59], v[104:107], 0
    v_mfma_f32_16x16x32_bf16 v[204:207], v[48:51], v[104:107], 0
    v_mfma_f32_16x16x32_bf16 v[212:215], v[64:67], v[104:107], 0
    s_nop 0
    v_mul_f32 v232, v184, v152
    v_mul_f32 v234, v192, v152
    v_mul_f32 v233, v185, v153
    v_mfma_f32_16x16x32_bf16 v[200:203], v[56:59], v[112:115], v[200:203]
    v_mul_f32 v235, v193, v153
    v_fma_f32 v232, v192, v160, v232
    v_fma_f32 v234, -v184, v160, v234
    v_mfma_f32_16x16x32_bf16 v[208:211], v[40:43], v[120:123], v[208:211]
    v_fma_f32 v233, v193, v161, v233
    v_fma_f32 v235, -v185, v161, v235
    v_cvt_pk_bf16_f32 v216, v232, v233
    v_mfma_f32_16x16x32_bf16 v[204:207], v[64:67], v[112:115], v[204:207]
    v_cvt_pk_bf16_f32 v220, v234, v235
    v_mul_f32 v236, v186, v154
    v_mul_f32 v238, v194, v154
    v_mfma_f32_16x16x32_bf16 v[212:215], v[48:51], v[120:123], v[212:215]
    v_mul_f32 v237, v187, v155
    v_mul_f32 v239, v195, v155
    v_fma_f32 v236, v194, v162, v236
    v_mfma_f32_16x16x32_bf16 v[200:203], v[44:47], v[108:111], v[200:203]
    v_fma_f32 v238, -v186, v162, v238
    v_fma_f32 v237, v195, v163, v237
    v_fma_f32 v239, -v187, v163, v239
    v_mfma_f32_16x16x32_bf16 v[208:211], v[60:63], v[108:111], v[208:211]
    v_cvt_pk_bf16_f32 v217, v236, v237
    v_cvt_pk_bf16_f32 v221, v238, v239
    v_mul_f32 v232, v188, v156
    v_mfma_f32_16x16x32_bf16 v[204:207], v[52:55], v[108:111], v[204:207]
    v_mul_f32 v234, v196, v156
    v_mul_f32 v233, v189, v157
    v_mul_f32 v235, v197, v157
    v_mfma_f32_16x16x32_bf16 v[212:215], v[68:71], v[108:111], v[212:215]
    v_fma_f32 v232, v196, v164, v232
    v_fma_f32 v234, -v188, v164, v234
    v_fma_f32 v233, v197, v165, v233
    v_mfma_f32_16x16x32_bf16 v[200:203], v[60:63], v[116:119], v[200:203]
    v_fma_f32 v235, -v189, v165, v235
    v_cvt_pk_bf16_f32 v218, v232, v233
    v_cvt_pk_bf16_f32 v222, v234, v235
    v_mfma_f32_16x16x32_bf16 v[208:211], v[44:47], v[124:127], v[208:211]
    v_mul_f32 v236, v190, v158
    v_mul_f32 v238, v198, v158
    v_mul_f32 v237, v191, v159
    v_mfma_f32_16x16x32_bf16 v[204:207], v[68:71], v[116:119], v[204:207]
    v_mul_f32 v239, v199, v159
    v_fma_f32 v236, v198, v166, v236
    v_fma_f32 v238, -v190, v166, v238
    v_mfma_f32_16x16x32_bf16 v[212:215], v[52:55], v[124:127], v[212:215]
    v_fma_f32 v237, v199, v167, v237
    v_fma_f32 v239, -v191, v167, v239
    v_cvt_pk_bf16_f32 v219, v236, v237
    v_cvt_pk_bf16_f32 v223, v238, v239
    s_nop 0
    v_mfma_f32_16x16x32_bf16 v[184:187], v[128:131], v[216:219], 0
    v_mul_f32 v232, v200, v152
    v_mul_f32 v234, v208, v152
    v_mul_f32 v233, v201, v153
    v_mfma_f32_16x16x32_bf16 v[192:195], v[128:131], v[220:223], 0
    v_mul_f32 v235, v209, v153
    v_fma_f32 v232, v208, v160, v232
    v_fma_f32 v234, -v200, v160, v234
    v_mfma_f32_16x16x32_bf16 v[188:191], v[132:135], v[216:219], 0
    v_fma_f32 v233, v209, v161, v233
    v_fma_f32 v235, -v201, v161, v235
    v_cvt_pk_bf16_f32 v224, v232, v233
    v_mfma_f32_16x16x32_bf16 v[196:199], v[132:135], v[220:223], 0
    v_cvt_pk_bf16_f32 v228, v234, v235
    v_mul_f32 v236, v202, v154
    v_mul_f32 v238, v210, v154
    v_mfma_f32_16x16x32_bf16 v[184:187], v[136:139], v[220:223], v[184:187]
    v_mul_f32 v237, v203, v155
    v_mul_f32 v239, v211, v155
    v_fma_f32 v236, v210, v162, v236
    v_mfma_f32_16x16x32_bf16 v[192:195], v[144:147], v[216:219], v[192:195]
    v_fma_f32 v238, -v202, v162, v238
    v_fma_f32 v237, v211, v163, v237
    v_fma_f32 v239, -v203, v163, v239
    v_mfma_f32_16x16x32_bf16 v[188:191], v[140:143], v[220:223], v[188:191]
    v_cvt_pk_bf16_f32 v225, v236, v237
    v_cvt_pk_bf16_f32 v229, v238, v239
    v_mul_f32 v232, v204, v156
    v_mfma_f32_16x16x32_bf16 v[196:199], v[148:151], v[216:219], v[196:199]
    v_mul_f32 v234, v212, v156
    v_mul_f32 v233, v205, v157
    v_mul_f32 v235, v213, v157
    v_fma_f32 v232, v212, v164, v232
    v_fma_f32 v234, -v204, v164, v234
    v_fma_f32 v233, v213, v165, v233
    v_fma_f32 v235, -v205, v165, v235
    v_cvt_pk_bf16_f32 v226, v232, v233
    v_cvt_pk_bf16_f32 v230, v234, v235
    v_mul_f32 v236, v206, v158
    v_mul_f32 v238, v214, v158
    v_mul_f32 v237, v207, v159
    v_mul_f32 v239, v215, v159
    v_fma_f32 v236, v214, v166, v236
    v_fma_f32 v238, -v206, v166, v238
    v_fma_f32 v237, v215, v167, v237
    v_fma_f32 v239, -v207, v167, v239
    v_cvt_pk_bf16_f32 v227, v236, v237
    v_cvt_pk_bf16_f32 v231, v238, v239
    s_waitcnt vmcnt(0)
    s_cmp_ge_u32 s3, 4
    s_cbranch_scc1 L_F_noc0
    s_add_u32 m0, s70, 0
    s_nop 0
    buffer_load_dwordx4 v250, s[72:75], s69 offen lds
    s_add_u32 m0, s70, 1024
    s_nop 0
    buffer_load_dwordx4 v251, s[72:75], s69 offen lds
    s_add_u32 m0, s70, 2048
    s_nop 0
    buffer_load_dwordx4 v252, s[72:75], s69 offen lds
    s_add_u32 m0, s70, 3072
    s_nop 0
    buffer_load_dwordx4 v253, s[72:75], s69 offen lds
    s_add_u32 m0, s70, 4096
    s_nop 0
    buffer_load_dwordx4 v254, s[72:75], s69 offen lds
    s_add_u32 s69, s69, 128
    s_cmp_eq_u32 s69, 1280
    s_cselect_b32 s69, 0, s69
L_F_noc0:
    v_mfma_f32_16x16x32_bf16 v[200:203], v[128:131], v[224:227], 0
    v_and_b32 v88, s7, v72
    v_lshlrev_b32 v72, 16, v72
    v_and_b32 v89, s7, v73
    v_mfma_f32_16x16x32_bf16 v[208:211], v[128:131], v[228:231], 0
    v_lshlrev_b32 v73, 16, v73
    v_and_b32 v90, s7, v74
    v_lshlrev_b32 v74, 16, v74
    v_mfma_f32_16x16x32_bf16 v[204:207], v[132:135], v[224:227], 0
    v_and_b32 v91, s7, v75
    v_lshlrev_b32 v75, 16, v75
    v_and_b32 v92, s7, v76
    v_mfma_f32_16x16x32_bf16 v[212:215], v[132:135], v[228:231], 0
    v_lshlrev_b32 v76, 16, v76
    v_and_b32 v93, s7, v77
    v_lshlrev_b32 v77, 16, v77
    v_mfma_f32_16x16x32_bf16 v[200:203], v[136:139], v[228:231], v[200:203]
    v_and_b32 v94, s7, v78
    v_lshlrev_b32 v78, 16, v78
    v_and_b32 v95, s7, v79
    v_mfma_f32_16x16x32_bf16 v[208:211], v[144:147], v[224:227], v[208:211]
    v_lshlrev_b32 v79, 16, v79
    v_and_b32 v96, s7, v80
    v_lshlrev_b32 v80, 16, v80
    v_mfma_f32_16x16x32_bf16 v[204:207], v[140:143], v[228:231], v[204:207]
    v_and_b32 v97, s7, v81
    v_lshlrev_b32 v81, 16, v81
    v_and_b32 v98, s7, v82
    v_mfma_f32_16x16x32_bf16 v[212:215], v[148:151], v[224:227], v[212:215]
    v_lshlrev_b32 v82, 16, v82
    v_and_b32 v99, s7, v83
    v_lshlrev_b32 v83, 16, v83
    v_and_b32 v100, s7, v84
    v_lshlrev_b32 v84, 16, v84
    v_and_b32 v101, s7, v85
    v_lshlrev_b32 v85, 16, v85
    v_and_b32 v102, s7, v86
    v_lshlrev_b32 v86, 16, v86
    v_and_b32 v103, s7, v87
    v_lshlrev_b32 v87, 16, v87
    s_cmp_lg_u32 s55, 0
    s_cbranch_scc1 L_F_ns2
    v_mul_f32 v72, 0.5, v72
    v_mul_f32 v88, 0.5, v88
    v_mul_f32 v73, 0.5, v73
    v_mul_f32 v89, 0.5, v89
    v_mul_f32 v74, 0.5, v74
    v_mul_f32 v90, 0.5, v90
    v_mul_f32 v75, 0.5, v75
    v_mul_f32 v91, 0.5, v91
    v_mul_f32 v76, 0.5, v76
    v_mul_f32 v92, 0.5, v92
    v_mul_f32 v77, 0.5, v77
    v_mul_f32 v93, 0.5, v93
    v_mul_f32 v78, 0.5, v78
    v_mul_f32 v94, 0.5, v94
    v_mul_f32 v79, 0.5, v79
    v_mul_f32 v95, 0.5, v95
L_F_ns2:
    v_mul_f32 v232, v184, v72
    v_mul_f32 v234, v192, v72
    v_mul_f32 v233, v185, v73
    v_mul_f32 v235, v193, v73
    v_fma_f32 v232, -v192, v88, v232
    v_fma_f32 v234, v184, v88, v234
    v_fma_f32 v233, -v193, v89, v233
    v_fma_f32 v235, v185, v89, v235
    v_cvt_pk_bf16_f32 v216, v232, v233
    v_cvt_pk_bf16_f32 v220, v234, v235
    v_mul_f32 v236, v186, v74
    v_mul_f32 v238, v194, v74
    v_mul_f32 v237, v187, v75
    v_mul_f32 v239, v195, v75
    v_fma_f32 v236, -v194, v90, v236
    v_fma_f32 v238, v186, v90, v238
    v_fma_f32 v237, -v195, v91, v237
    v_fma_f32 v239, v187, v91, v239
    v_cvt_pk_bf16_f32 v217, v236, v237
    v_cvt_pk_bf16_f32 v221, v238, v239
    v_mul_f32 v232, v188, v76
    v_mul_f32 v234, v196, v76
    v_mul_f32 v233, v189, v77
    v_mul_f32 v235, v197, v77
    v_fma_f32 v232, -v196, v92, v232
    v_fma_f32 v234, v188, v92, v234
    v_fma_f32 v233, -v197, v93, v233
    v_fma_f32 v235, v189, v93, v235
    v_cvt_pk_bf16_f32 v218, v232, v233
    v_cvt_pk_bf16_f32 v222, v234, v235
    v_mul_f32 v236, v190, v78
    v_mul_f32 v238, v198, v78
    v_mul_f32 v237, v191, v79
    v_mul_f32 v239, v199, v79
    v_fma_f32 v236, -v198, v94, v236
    v_fma_f32 v238, v190, v94, v238
    v_fma_f32 v237, -v199, v95, v237
    v_fma_f32 v239, v191, v95, v239
    v_cvt_pk_bf16_f32 v219, v236, v237
    v_cvt_pk_bf16_f32 v223, v238, v239
    s_cmp_ge_u32 s3, 4
    s_cbranch_scc1 L_F_noc1
    s_add_u32 m0, s70, 20480
    s_nop 0
    buffer_load_dwordx4 v250, s[72:75], s69 offen lds
    s_add_u32 m0, s70, 21504
    s_nop 0
    buffer_load_dwordx4 v251, s[72:75], s69 offen lds
    s_add_u32 m0, s70, 22528
    s_nop 0
    buffer_load_dwordx4 v252, s[72:75], s69 offen lds
    s_add_u32 m0, s70, 23552
    s_nop 0
    buffer_load_dwordx4 v253, s[72:75], s69 offen lds
    s_add_u32 m0, s70, 24576
    s_nop 0
    buffer_load_dwordx4 v254, s[72:75], s69 offen lds
    s_add_u32 s69, s69, 128
    s_cmp_eq_u32 s69, 1280
    s_cselect_b32 s69, 0, s69
L_F_noc1:
    v_mfma_f32_16x16x32_bf16 v[184:187], v[216:219], v[128:131], 0
    v_mul_f32 v232, v200, v80
    v_mul_f32 v234, v208, v80
    v_mul_f32 v233, v201, v81
    v_mfma_f32_16x16x32_bf16 v[192:195], v[220:223], v[128:131], 0
    v_mul_f32 v235, v209, v81
    v_fma_f32 v232, -v208, v96, v232
    v_fma_f32 v234, v200, v96, v234
    v_mfma_f32_16x16x32_bf16 v[188:191], v[216:219], v[132:135], 0
    v_fma_f32 v233, -v209, v97, v233
    v_fma_f32 v235, v201, v97, v235
    v_cvt_pk_bf16_f32 v224, v232, v233
    v_mfma_f32_16x16x32_bf16 v[196:199], v[220:223], v[132:135], 0
    v_cvt_pk_bf16_f32 v228, v234, v235
    v_mul_f32 v236, v202, v82
    v_mul_f32 v238, v210, v82
    v_mfma_f32_16x16x32_bf16 v[184:187], v[220:223], v[144:147], v[184:187]
    v_mul_f32 v237, v203, v83
    v_mul_f32 v239, v211, v83
    v_fma_f32 v236, -v210, v98, v236
    v_mfma_f32_16x16x32_bf16 v[192:195], v[216:219], v[136:139], v[192:195]
    v_fma_f32 v238, v202, v98, v238
    v_fma_f32 v237, -v211, v99, v237
    v_fma_f32 v239, v203, v99, v239
    v_mfma_f32_16x16x32_bf16 v[188:191], v[220:223], v[148:151], v[188:191]
    v_cvt_pk_bf16_f32 v225, v236, v237
    v_cvt_pk_bf16_f32 v229, v238, v239
    v_mul_f32 v232, v204, v84
    v_mfma_f32_16x16x32_bf16 v[196:199], v[216:219], v[140:143], v[196:199]
    v_mul_f32 v234, v212, v84
    v_mul_f32 v233, v205, v85
    v_mul_f32 v235, v213, v85
    v_fma_f32 v232, -v212, v100, v232
    v_fma_f32 v234, v204, v100, v234
    v_fma_f32 v233, -v213, v101, v233
    v_fma_f32 v235, v205, v101, v235
    v_cvt_pk_bf16_f32 v226, v232, v233
    v_cvt_pk_bf16_f32 v230, v234, v235
    v_mul_f32 v236, v206, v86
    v_mul_f32 v238, v214, v86
    v_mul_f32 v237, v207, v87
    v_mul_f32 v239, v215, v87
    v_fma_f32 v236, -v214, v102, v236
    v_fma_f32 v238, v206, v102, v238
    v_fma_f32 v237, -v215, v103, v237
    v_fma_f32 v239, v207, v103, v239
    v_cvt_pk_bf16_f32 v227, v236, v237
    v_cvt_pk_bf16_f32 v231, v238, v239
    s_nop 0
    v_mfma_f32_16x16x32_bf16 v[200:203], v[224:227], v[128:131], 0
    v_mul_f32 v232, v184, v168
    v_mul_f32 v234, v192, v168
    v_mul_f32 v233, v185, v169
    v_mfma_f32_16x16x32_bf16 v[208:211], v[228:231], v[128:131], 0
    v_mul_f32 v235, v193, v169
    v_fma_f32 v232, -v192, v176, v232
    v_fma_f32 v234, v184, v176, v234
    v_mfma_f32_16x16x32_bf16 v[204:207], v[224:227], v[132:135], 0
    v_fma_f32 v233, -v193, v177, v233
    v_fma_f32 v235, v185, v177, v235
    v_cvt_pk_bf16_f32 v216, v232, v233
    v_mfma_f32_16x16x32_bf16 v[212:215], v[228:231], v[132:135], 0
    v_cvt_pk_bf16_f32 v220, v234, v235
    v_mul_f32 v236, v186, v170
    v_mul_f32 v238, v194, v170
    v_mfma_f32_16x16x32_bf16 v[200:203], v[228:231], v[144:147], v[200:203]
    v_mul_f32 v237, v187, v171
    v_mul_f32 v239, v195, v171
    v_fma_f32 v236, -v194, v178, v236
    v_mfma_f32_16x16x32_bf16 v[208:211], v[224:227], v[136:139], v[208:211]
    v_fma_f32 v238, v186, v178, v238
    v_fma_f32 v237, -v195, v179, v237
    v_fma_f32 v239, v187, v179, v239
    v_mfma_f32_16x16x32_bf16 v[204:207], v[228:231], v[148:151], v[204:207]
    v_cvt_pk_bf16_f32 v217, v236, v237
    v_cvt_pk_bf16_f32 v221, v238, v239
    ds_write_b64 v243, v[216:217] offset:0
    v_mfma_f32_16x16x32_bf16 v[212:215], v[224:227], v[140:143], v[212:215]
    ds_write_b64 v243, v[220:221] offset:4096
    v_mul_f32 v232, v188, v172
    v_mul_f32 v234, v196, v172
    v_mul_f32 v233, v189, v173
    v_mul_f32 v235, v197, v173
    v_fma_f32 v232, -v196, v180, v232
    v_fma_f32 v234, v188, v180, v234
    v_fma_f32 v233, -v197, v181, v233
    v_fma_f32 v235, v189, v181, v235
    v_cvt_pk_bf16_f32 v218, v232, v233
    v_cvt_pk_bf16_f32 v222, v234, v235
    v_mul_f32 v236, v190, v174
    v_mul_f32 v238, v198, v174
    v_mul_f32 v237, v191, v175
    v_mul_f32 v239, v199, v175
    v_fma_f32 v236, -v198, v182, v236
    v_fma_f32 v238, v190, v182, v238
    v_fma_f32 v237, -v199, v183, v237
    v_fma_f32 v239, v191, v183, v239
    v_cvt_pk_bf16_f32 v219, v236, v237
    v_cvt_pk_bf16_f32 v223, v238, v239
    ds_write_b64 v243, v[218:219] offset:2048
    ds_write_b64 v243, v[222:223] offset:6144
    s_cmp_ge_u32 s3, 4
    s_cbranch_scc1 L_F_noc2
    s_add_u32 m0, s70, 40960
    s_nop 0
    buffer_load_dwordx4 v250, s[72:75], s69 offen lds
    s_add_u32 m0, s70, 41984
    s_nop 0
    buffer_load_dwordx4 v251, s[72:75], s69 offen lds
    s_add_u32 m0, s70, 43008
    s_nop 0
    buffer_load_dwordx4 v252, s[72:75], s69 offen lds
    s_add_u32 m0, s70, 44032
    s_nop 0
    buffer_load_dwordx4 v253, s[72:75], s69 offen lds
    s_add_u32 m0, s70, 45056
    s_nop 0
    buffer_load_dwordx4 v254, s[72:75], s69 offen lds
    s_add_u32 s69, s69, 128
    s_cmp_eq_u32 s69, 1280
    s_cselect_b32 s69, 0, s69
L_F_noc2:
    v_mul_f32 v232, v200, v168
    v_mul_f32 v234, v208, v168
    v_mul_f32 v233, v201, v169
    v_mul_f32 v235, v209, v169
    v_fma_f32 v232, -v208, v176, v232
    v_fma_f32 v234, v200, v176, v234
    v_fma_f32 v233, -v209, v177, v233
    v_fma_f32 v235, v201, v177, v235
    v_cvt_pk_bf16_f32 v224, v232, v233
    v_cvt_pk_bf16_f32 v228, v234, v235
    v_mul_f32 v236, v202, v170
    v_mul_f32 v238, v210, v170
    v_mul_f32 v237, v203, v171
    v_mul_f32 v239, v211, v171
    v_fma_f32 v236, -v210, v178, v236
    v_fma_f32 v238, v202, v178, v238
    v_fma_f32 v237, -v211, v179, v237
    v_fma_f32 v239, v203, v179, v239
    v_cvt_pk_bf16_f32 v225, v236, v237
    v_cvt_pk_bf16_f32 v229, v238, v239
    ds_write_b64 v243, v[224:225] offset:8192
    ds_write_b64 v243, v[228:229] offset:12288
    v_mul_f32 v232, v204, v172
    v_mul_f32 v234, v212, v172
    v_mul_f32 v233, v205, v173
    v_mul_f32 v235, v213, v173
    v_fma_f32 v232, -v212, v180, v232
    v_fma_f32 v234, v204, v180, v234
    v_fma_f32 v233, -v213, v181, v233
    v_fma_f32 v235, v205, v181, v235
    v_cvt_pk_bf16_f32 v226, v232, v233
    v_cvt_pk_bf16_f32 v230, v234, v235
    v_mul_f32 v236, v206, v174
    v_mul_f32 v238, v214, v174
    v_mul_f32 v237, v207, v175
    v_mul_f32 v239, v215, v175
    v_fma_f32 v236, -v214, v182, v236
    v_fma_f32 v238, v206, v182, v238
    v_fma_f32 v237, -v215, v183, v237
    v_fma_f32 v239, v207, v183, v239
    v_cvt_pk_bf16_f32 v227, v236, v237
    v_cvt_pk_bf16_f32 v231, v238, v239
    ds_write_b64 v243, v[226:227] offset:10240
    ds_write_b64 v243, v[230:231] offset:14336
    s_cmp_ge_u32 s3, 4
    s_cbranch_scc1 L_F_noc3
    s_add_u32 m0, s70, 61440
    s_nop 0
    buffer_load_dwordx4 v250, s[72:75], s69 offen lds
    s_add_u32 m0, s70, 62464
    s_nop 0
    buffer_load_dwordx4 v251, s[72:75], s69 offen lds
    s_add_u32 m0, s70, 63488
    s_nop 0
    buffer_load_dwordx4 v252, s[72:75], s69 offen lds
    s_add_u32 m0, s70, 64512
    s_nop 0
    buffer_load_dwordx4 v253, s[72:75], s69 offen lds
    s_add_u32 m0, s70, 65536
    s_nop 0
    buffer_load_dwordx4 v254, s[72:75], s69 offen lds
    s_add_u32 s69, s69, 128
    s_cmp_eq_u32 s69, 1280
    s_cselect_b32 s69, 0, s69
L_F_noc3:
    s_and_b32 s10, s3, 4
    s_add_u32 s10, s10, 159296
    v_mov_b32 v232, s10
    v_mov_b32 v233, 1
    s_mov_b64 exec, 1
    ds_add_u32 v232, v233
    s_mov_b64 exec, -1
    v_mov_b32 v232, s10
    s_mov_b32 s15, 0x800000
L_lw10:
    ds_read_b32 v233, v232
    s_waitcnt lgkmcnt(0)
    v_readfirstlane_b32 s0, v233
    s_cmp_ge_u32 s0, 4
    s_cbranch_scc1 L_lw10_ok
    s_sub_u32 s15, s15, 1
    s_cbranch_scc0 L_lw10
L_lw10_ok:
    ds_read_b128 v[8:11], v244 offset:0
    ds_read_b128 v[16:19], v244 offset:2048
    ds_read_b128 v[24:27], v244 offset:4096
    ds_read_b128 v[32:35], v244 offset:6144
    ds_read_b128 v[12:15], v245 offset:0
    ds_read_b128 v[20:23], v245 offset:2048
    ds_read_b128 v[28:31], v245 offset:4096
    ds_read_b128 v[36:39], v245 offset:6144
    ds_read_b128 v[40:43], v244 offset:8192
    ds_read_b128 v[48:51], v244 offset:10240
    ds_read_b128 v[56:59], v244 offset:12288
    ds_read_b128 v[64:67], v244 offset:14336
    s_waitcnt lgkmcnt(8)
    ds_read_b128 v[44:47], v245 offset:8192
    ds_read_b128 v[52:55], v245 offset:10240
    ds_read_b128 v[60:63], v245 offset:12288
    ds_read_b128 v[68:71], v245 offset:14336
    v_mfma_f32_16x16x32_bf16 v[184:187], v[104:107], v[8:11], 0
    v_mfma_f32_16x16x32_bf16 v[192:195], v[104:107], v[24:27], 0
    v_mfma_f32_16x16x32_bf16 v[188:191], v[104:107], v[16:19], 0
    v_mfma_f32_16x16x32_bf16 v[196:199], v[104:107], v[32:35], 0
    v_mfma_f32_16x16x32_bf16 v[184:187], v[120:123], v[24:27], v[184:187]
    v_mfma_f32_16x16x32_bf16 v[192:195], v[112:115], v[8:11], v[192:195]
    v_mfma_f32_16x16x32_bf16 v[188:191], v[120:123], v[32:35], v[188:191]
    v_mfma_f32_16x16x32_bf16 v[196:199], v[112:115], v[16:19], v[196:199]
    s_waitcnt lgkmcnt(8)
    v_mfma_f32_16x16x32_bf16 v[184:187], v[108:111], v[12:15], v[184:187]
    v_mfma_f32_16x16x32_bf16 v[192:195], v[108:111], v[28:31], v[192:195]
    v_mfma_f32_16x16x32_bf16 v[188:191], v[108:111], v[20:23], v[188:191]
    v_mfma_f32_16x16x32_bf16 v[196:199], v[108:111], v[36:39], v[196:199]
    v_mfma_f32_16x16x32_bf16 v[184:187], v[124:127], v[28:31], v[184:187]
    v_mfma_f32_16x16x32_bf16 v[192:195], v[116:119], v[12:15], v[192:195]
    v_mfma_f32_16x16x32_bf16 v[188:191], v[124:127], v[36:39], v[188:191]
    v_mfma_f32_16x16x32_bf16 v[196:199], v[116:119], v[20:23], v[196:199]
    s_waitcnt lgkmcnt(0)
    v_mfma_f32_16x16x32_bf16 v[200:203], v[104:107], v[40:43], 0
    v_mfma_f32_16x16x32_bf16 v[208:211], v[104:107], v[56:59], 0
    v_mfma_f32_16x16x32_bf16 v[204:207], v[104:107], v[48:51], 0
    v_mfma_f32_16x16x32_bf16 v[212:215], v[104:107], v[64:67], 0
    v_mfma_f32_16x16x32_bf16 v[200:203], v[120:123], v[56:59], v[200:203]
    v_cvt_pk_bf16_f32 v216, v184, v185
    v_cvt_pk_bf16_f32 v217, v186, v187
    v_cvt_pk_bf16_f32 v220, v192, v193
    v_mfma_f32_16x16x32_bf16 v[208:211], v[112:115], v[40:43], v[208:211]
    v_cvt_pk_bf16_f32 v221, v194, v195
    v_cvt_pk_bf16_f32 v224, v188, v189
    v_cvt_pk_bf16_f32 v225, v190, v191
    v_mfma_f32_16x16x32_bf16 v[204:207], v[120:123], v[64:67], v[204:207]
    v_cvt_pk_bf16_f32 v228, v196, v197
    v_cvt_pk_bf16_f32 v229, v198, v199
    v_mfma_f32_16x16x32_bf16 v[212:215], v[112:115], v[48:51], v[212:215]
    v_mfma_f32_16x16x32_bf16 v[200:203], v[108:111], v[44:47], v[200:203]
    v_mfma_f32_16x16x32_bf16 v[208:211], v[108:111], v[60:63], v[208:211]
    v_mfma_f32_16x16x32_bf16 v[204:207], v[108:111], v[52:55], v[204:207]
    v_mfma_f32_16x16x32_bf16 v[212:215], v[108:111], v[68:71], v[212:215]
    v_mfma_f32_16x16x32_bf16 v[200:203], v[124:127], v[60:63], v[200:203]
    v_mfma_f32_16x16x32_bf16 v[208:211], v[116:119], v[44:47], v[208:211]
    v_mfma_f32_16x16x32_bf16 v[204:207], v[124:127], v[68:71], v[204:207]
    v_mfma_f32_16x16x32_bf16 v[212:215], v[116:119], v[52:55], v[212:215]
    s_nop 4
    v_cvt_pk_bf16_f32 v218, v200, v201
    v_cvt_pk_bf16_f32 v219, v202, v203
    buffer_store_dwordx4 v[216:219], v246, s[56:59], s51 offen sc1
    v_cvt_pk_bf16_f32 v222, v208, v209
    v_cvt_pk_bf16_f32 v223, v210, v211
    buffer_store_dwordx4 v[220:223], v246, s[56:59], s52 offen sc1
    v_cvt_pk_bf16_f32 v226, v204, v205
    v_cvt_pk_bf16_f32 v227, v206, v207
    buffer_store_dwordx4 v[224:227], v247, s[56:59], s51 offen sc1
    v_cvt_pk_bf16_f32 v230, v212, v213
    v_cvt_pk_bf16_f32 v231, v214, v215
    buffer_store_dwordx4 v[228:231], v247, s[56:59], s52 offen sc1
    s_cmp_lg_u32 s55, 0
    s_cbranch_scc1 L_F_ns3
    s_cmp_lg_u32 s48, 0
    s_cbranch_scc1 L_F_nyq
    buffer_store_dwordx2 v[222:223], v246, s[56:59], s53 offen offset:8 sc1
    buffer_store_dwordx2 v[230:231], v247, s[56:59], s53 offen offset:8 sc1
    s_branch L_F_ns3
L_F_nyq:
    buffer_store_dwordx2 v[216:217], v246, s[56:59], s53 offen sc1
    buffer_store_dwordx2 v[224:225], v247, s[56:59], s53 offen sc1
L_F_ns3:
    v_mov_b32 v232, 159452
    v_mov_b32 v233, 1
    s_mov_b64 exec, 1
    s_waitcnt vmcnt(0)
    ds_add_rtn_u32 v233, v232, v233
    s_waitcnt lgkmcnt(0)
    v_readfirstlane_b32 s10, v233
    s_mov_b64 exec, -1
    s_cmp_lg_u32 s10, 7
    s_cbranch_scc1 L_F_nz
    v_mov_b32 v232, s68
    s_lshl_b32 s15, s6, 7
    v_mov_b32 v233, 16384
    buffer_store_dword v232, v233, s[56:59], s15 offen sc1
L_F_nz:
    s_mov_b32 s71, 0
    s_cmp_ge_u32 s3, 4
    s_cbranch_scc1 L_F_g1
    v_mov_b32 v232, 159444
    v_mov_b32 v233, 1
    s_mov_b64 exec, 1
    ds_add_u32 v232, v233
    s_mov_b64 exec, -1
    s_branch L_P3c
L_F_g1:
    s_add_u32 s69, s69, 512
    s_sub_u32 s10, s69, 1280
    s_cmp_ge_u32 s69, 1280
    s_cselect_b32 s69, s10, s69
    v_mov_b32 v232, 159452
    s_mov_b32 s15, 0x800000
L_lw11:
    ds_read_b32 v233, v232
    s_waitcnt lgkmcnt(0)
    v_readfirstlane_b32 s0, v233
    s_cmp_ge_u32 s0, 8
    s_cbranch_scc1 L_lw11_ok
    s_sub_u32 s15, s15, 1
    s_cbranch_scc0 L_lw11
L_lw11_ok:
    s_add_u32 m0, s70, 81920
    s_nop 0
    buffer_load_dwordx4 v250, s[72:75], s69 offen lds
    s_add_u32 m0, s70, 82944
    s_nop 0
    buffer_load_dwordx4 v251, s[72:75], s69 offen lds
    s_add_u32 m0, s70, 83968
    s_nop 0
    buffer_load_dwordx4 v252, s[72:75], s69 offen lds
    s_add_u32 m0, s70, 84992
    s_nop 0
    buffer_load_dwordx4 v253, s[72:75], s69 offen lds
    s_add_u32 m0, s70, 86016
    s_nop 0
    buffer_load_dwordx4 v254, s[72:75], s69 offen lds
    s_add_u32 s69, s69, 128
    s_cmp_eq_u32 s69, 1280
    s_cselect_b32 s69, 0, s69
    s_add_u32 m0, s70, 102400
    s_nop 0
    buffer_load_dwordx4 v250, s[72:75], s69 offen lds
    s_add_u32 m0, s70, 103424
    s_nop 0
    buffer_load_dwordx4 v251, s[72:75], s69 offen lds
    s_add_u32 m0, s70, 104448
    s_nop 0
    buffer_load_dwordx4 v252, s[72:75], s69 offen lds
    s_add_u32 m0, s70, 105472
    s_nop 0
    buffer_load_dwordx4 v253, s[72:75], s69 offen lds
    s_add_u32 m0, s70, 106496
    s_nop 0
    buffer_load_dwordx4 v254, s[72:75], s69 offen lds
    s_add_u32 s69, s69, 128
    s_cmp_eq_u32 s69, 1280
    s_cselect_b32 s69, 0, s69
    s_add_u32 m0, s70, 122880
    s_nop 0
    buffer_load_dwordx4 v250, s[72:75], s69 offen lds
    s_add_u32 m0, s70, 123904
    s_nop 0
    buffer_load_dwordx4 v251, s[72:75], s69 offen lds
    s_add_u32 m0, s70, 124928
    s_nop 0
    buffer_load_dwordx4 v252, s[72:75], s69 offen lds
    s_add_u32 m0, s70, 125952
    s_nop 0
    buffer_load_dwordx4 v253, s[72:75], s69 offen lds
    s_add_u32 m0, s70, 126976
    s_nop 0
    buffer_load_dwordx4 v254, s[72:75], s69 offen lds
    s_add_u32 s69, s69, 128
    s_cmp_eq_u32 s69, 1280
    s_cselect_b32 s69, 0, s69
    v_mov_b32 v232, 159448
    s_mov_b32 s15, 0x800000
L_lw12:
    ds_read_b32 v233, v232
    s_waitcnt lgkmcnt(0)
    v_readfirstlane_b32 s0, v233
    s_cmp_ge_u32 s0, 4
    s_cbranch_scc1 L_lw12_ok
    s_sub_u32 s15, s15, 1
    s_cbranch_scc0 L_lw12
L_lw12_ok:
    s_branch L_P3l
L_P3c:
    v_and_b32 v2, 15, v0
    v_lshrrev_b32 v3, 4, v0
    v_lshrrev_b32 v5, 1, v2
    v_xor_b32 v5, v5, v3
    v_lshlrev_b32 v5, 4, v5
    v_lshl_add_u32 v5, v2, 7, v5
    s_and_b32 s6, s3, 1
    s_mul_i32 s10, s6, 10240
    v_add_u32 v7, s10, v5
    v_xor_b32 v8, 64, v7
    v_mov_b32 v250, 159444
    s_mov_b32 s15, 0x800000
L_lw13:
    ds_read_b32 v251, v250
    s_waitcnt lgkmcnt(0)
    v_readfirstlane_b32 s0, v251
    s_cmp_ge_u32 s0, 4
    s_cbranch_scc1 L_lw13_ok
    s_sub_u32 s15, s15, 1
    s_cbranch_scc0 L_lw13
L_lw13_ok:
    ds_read_b128 v[80:83], v7 offset:0
    ds_read_b128 v[84:87], v7 offset:2048
    ds_read_b128 v[88:91], v7 offset:4096
    ds_read_b128 v[92:95], v7 offset:6144
    ds_read_b128 v[96:99], v7 offset:8192
    ds_read_b128 v[100:103], v8 offset:0
    ds_read_b128 v[104:107], v8 offset:2048
    ds_read_b128 v[108:111], v8 offset:4096
    ds_read_b128 v[112:115], v8 offset:6144
    ds_read_b128 v[116:119], v8 offset:8192
    ds_read_b128 v[120:123], v7 offset:20480
    ds_read_b128 v[124:127], v7 offset:22528
    ds_read_b128 v[128:131], v7 offset:24576
    ds_read_b128 v[132:135], v7 offset:26624
    ds_read_b128 v[136:139], v7 offset:28672
    s_lshr_b32 s10, s65, 1
    s_and_b32 s12, s65, 1
    s_lshl3_add_u32 s7, s10, s12
    s_lshl1_add_u32 s11, s3, s7
    v_and_b32 v14, 3, v0
    v_lshlrev_b32 v14, 3, v14
    v_lshrrev_b32 v5, 2, v0
    v_lshl_add_u32 v5, s11, 4, v5
    v_mul_u32_u24 v13, 1280, v5
    v_add_u32 v13, v13, v14
    s_mov_b32 s8, s16
    s_mov_b32 s9, s17
    s_mov_b32 s10, 2621440
    s_mov_b32 s11, 0x20000
    s_mov_b32 s12, s38
    s_mov_b32 s13, s39
    s_mov_b32 s14, 1280
    s_mov_b32 s15, 0x20000
    s_lshl_b32 s7, s60, 1
    buffer_load_dwordx2 v[240:241], v13, s[8:11], s7 offen
    buffer_load_dwordx2 v[64:65], v14, s[12:15], s7 offen
    s_lshl_b32 s7, s61, 1
    buffer_load_dwordx2 v[242:243], v13, s[8:11], s7 offen
    buffer_load_dwordx2 v[66:67], v14, s[12:15], s7 offen
    s_lshl_b32 s7, s62, 1
    buffer_load_dwordx2 v[244:245], v13, s[8:11], s7 offen
    buffer_load_dwordx2 v[68:69], v14, s[12:15], s7 offen
    s_lshl_b32 s7, s63, 1
    buffer_load_dwordx2 v[246:247], v13, s[8:11], s7 offen
    buffer_load_dwordx2 v[70:71], v14, s[12:15], s7 offen
    s_lshl_b32 s7, s64, 1
    buffer_load_dwordx2 v[248:249], v13, s[8:11], s7 offen
    buffer_load_dwordx2 v[72:73], v14, s[12:15], s7 offen
    s_waitcnt lgkmcnt(10)
    ds_read_b128 v[140:143], v8 offset:20480
    ds_read_b128 v[144:147], v8 offset:22528
    ds_read_b128 v[148:151], v8 offset:24576
    ds_read_b128 v[152:155], v8 offset:26624
    ds_read_b128 v[156:159], v8 offset:28672
    s_waitcnt lgkmcnt(10)
    ds_read_b128 v[160:163], v7 offset:40960
    ds_read_b128 v[164:167], v7 offset:43008
    ds_read_b128 v[168:171], v7 offset:45056
    ds_read_b128 v[172:175], v7 offset:47104
    ds_read_b128 v[176:179], v7 offset:49152
    s_waitcnt lgkmcnt(10)
    ds_read_b128 v[180:183], v8 offset:40960
    ds_read_b128 v[184:187], v8 offset:43008
    ds_read_b128 v[188:191], v8 offset:45056
    ds_read_b128 v[192:195], v8 offset:47104
    ds_read_b128 v[196:199], v8 offset:49152
    s_cmp_eq_u32 s71, 0
    s_cbranch_scc1 L_P3c_nh
    v_mov_b32 v5, 159728
    v_mov_b32 v6, 1
    s_mov_b64 exec, 1
    s_waitcnt vmcnt(10)
    ds_add_rtn_u32 v6, v5, v6
    s_waitcnt lgkmcnt(0)
    v_readfirstlane_b32 s10, v6
    s_mov_b64 exec, -1
    s_cmp_lg_u32 s10, 3
    s_cbranch_scc1 L_P3c_nh
    v_mov_b32 v5, s68
    v_mov_b32 v6, 0
    s_cmp_eq_u64 s[50:51], 0
    s_cbranch_scc1 L_P3c_fl
    buffer_store_dword v5, v6, s[56:59], s52 offen sc1
    s_branch L_P3c_nh
L_P3c_fl:
    buffer_store_dword v5, v6, s[56:59], s52 offen
L_P3c_nh:
    v_mov_b32 v250, 159448
    v_mov_b32 v251, 1
    s_mov_b64 exec, 1
    ds_add_u32 v250, v251
    s_mov_b64 exec, -1
    v_lshlrev_b32 v4, 4, v0
    v_add_u32 v9, 61440, v7
    v_add_u32 v10, 61440, v8
    v_add_u32 v11, 122880, v7
    v_add_u32 v12, 122880, v8
    s_lshr_b32 s10, s65, 1
    s_and_b32 s12, s65, 1
    s_lshl3_add_u32 s7, s10, s12
    s_and_b32 s12, s3, 2
    s_lshl1_add_u32 s12, s12, s7
    s_mul_i32 s12, s12, 40960
    s_lshl_b32 s13, s6, 10
    s_add_u32 s12, s12, s13
    s_add_u32 s12, s12, 8093696
    s_lshl_b32 s13, s67, 12
    v_add_u32 v6, 81920, v4
    s_waitcnt vmcnt(0)
    s_mov_b32 s14, 0xffff0000
    v_lshlrev_b32 v32, 16, v240
    v_and_b32 v33, s14, v240
    v_lshlrev_b32 v34, 16, v64
    v_and_b32 v35, s14, v64
    v_pk_mul_f32 v[32:33], v[32:33], v[34:35]
    v_cvt_pk_bf16_f32 v240, v32, v33
    v_lshlrev_b32 v32, 16, v241
    v_and_b32 v33, s14, v241
    v_lshlrev_b32 v34, 16, v65
    v_and_b32 v35, s14, v65
    v_pk_mul_f32 v[32:33], v[32:33], v[34:35]
    v_cvt_pk_bf16_f32 v241, v32, v33
    v_lshlrev_b32 v32, 16, v242
    v_and_b32 v33, s14, v242
    v_lshlrev_b32 v34, 16, v66
    v_and_b32 v35, s14, v66
    v_pk_mul_f32 v[32:33], v[32:33], v[34:35]
    v_cvt_pk_bf16_f32 v242, v32, v33
    v_lshlrev_b32 v32, 16, v243
    v_and_b32 v33, s14, v243
    v_lshlrev_b32 v34, 16, v67
    v_and_b32 v35, s14, v67
    v_pk_mul_f32 v[32:33], v[32:33], v[34:35]
    v_cvt_pk_bf16_f32 v243, v32, v33
    v_lshlrev_b32 v32, 16, v244
    v_and_b32 v33, s14, v244
    v_lshlrev_b32 v34, 16, v68
    v_and_b32 v35, s14, v68
    v_pk_mul_f32 v[32:33], v[32:33], v[34:35]
    v_cvt_pk_bf16_f32 v244, v32, v33
    v_lshlrev_b32 v32, 16, v245
    v_and_b32 v33, s14, v245
    v_lshlrev_b32 v34, 16, v69
    v_and_b32 v35, s14, v69
    v_pk_mul_f32 v[32:33], v[32:33], v[34:35]
    v_cvt_pk_bf16_f32 v245, v32, v33
    v_lshlrev_b32 v32, 16, v246
    v_and_b32 v33, s14, v246
    v_lshlrev_b32 v34, 16, v70
    v_and_b32 v35, s14, v70
    v_pk_mul_f32 v[32:33], v[32:33], v[34:35]
    v_cvt_pk_bf16_f32 v246, v32, v33
    v_lshlrev_b32 v32, 16, v247
    v_and_b32 v33, s14, v247
    v_lshlrev_b32 v34, 16, v71
    v_and_b32 v35, s14, v71
    v_pk_mul_f32 v[32:33], v[32:33], v[34:35]
    v_cvt_pk_bf16_f32 v247, v32, v33
    v_lshlrev_b32 v32, 16, v248
    v_and_b32 v33, s14, v248
    v_lshlrev_b32 v34, 16, v72
    v_and_b32 v35, s14, v72
    v_pk_mul_f32 v[32:33], v[32:33], v[34:35]
    v_cvt_pk_bf16_f32 v248, v32, v33
    v_lshlrev_b32 v32, 16, v249
    v_and_b32 v33, s14, v249
    v_lshlrev_b32 v34, 16, v73
    v_and_b32 v35, s14, v73
    v_pk_mul_f32 v[32:33], v[32:33], v[34:35]
    v_cvt_pk_bf16_f32 v249, v32, v33
    s_cmp_lg_u32 s3, 0
    s_cbranch_scc1 L_P3c_w
    v_min_u32 v16, 9, v0
    s_lshl_b32 s10, s10, 5
    v_add_lshl_u32 v16, v16, s10, 2
    v_add_u32 v16, 32768, v16
    s_mov_b32 s15, 0x20000
    s_mov_b32 s1, 0
L_poll14:
    buffer_load_dword v17, v16, s[56:59], s1 offen sc1
    s_waitcnt vmcnt(0)
    v_xor_b32 v17, s68, v17
    v_cmp_ne_u32 vcc, 0, v17
    s_cbranch_vccz L_poll14_ok
    s_sleep 2
    s_sub_u32 s15, s15, 1
    s_cbranch_scc0 L_poll14
L_poll14_ok:
    v_mov_b32 v16, 159584
    v_mov_b32 v17, 1
    s_mov_b64 exec, 1
    ds_add_u32 v16, v17
    s_mov_b64 exec, -1
L_P3c_w:
    v_mov_b32 v16, 159584
    s_mov_b32 s15, 0x800000
L_lw15:
    ds_read_b32 v17, v16
    s_waitcnt lgkmcnt(0)
    v_readfirstlane_b32 s0, v17
    s_cmp_ge_u32 s0, 1
    s_cbranch_scc1 L_lw15_ok
    s_sub_u32 s15, s15, 1
    s_cbranch_scc0 L_lw15
L_lw15_ok:
    s_add_u32 s14, s12, s13
    buffer_load_dwordx4 v[16:19], v4, s[56:59], s14 offen offset:0 sc1
    buffer_load_dwordx4 v[20:23], v6, s[56:59], s14 offen offset:0 sc1
    buffer_load_dwordx4 v[24:27], v4, s[56:59], s14 offen offset:2048 sc1
    buffer_load_dwordx4 v[28:31], v6, s[56:59], s14 offen offset:2048 sc1
    s_add_u32 s13, s13, 4096
    s_cmp_eq_u32 s13, 40960
    s_cselect_b32 s13, 0, s13
    s_add_u32 s14, s12, s13
    buffer_load_dwordx4 v[32:35], v4, s[56:59], s14 offen offset:0 sc1
    buffer_load_dwordx4 v[36:39], v6, s[56:59], s14 offen offset:0 sc1
    buffer_load_dwordx4 v[40:43], v4, s[56:59], s14 offen offset:2048 sc1
    buffer_load_dwordx4 v[44:47], v6, s[56:59], s14 offen offset:2048 sc1
    s_add_u32 s13, s13, 4096
    s_cmp_eq_u32 s13, 40960
    s_cselect_b32 s13, 0, s13
    s_add_u32 s14, s12, s13
    buffer_load_dwordx4 v[48:51], v4, s[56:59], s14 offen offset:0 sc1
    buffer_load_dwordx4 v[52:55], v6, s[56:59], s14 offen offset:0 sc1
    buffer_load_dwordx4 v[56:59], v4, s[56:59], s14 offen offset:2048 sc1
    buffer_load_dwordx4 v[60:63], v6, s[56:59], s14 offen offset:2048 sc1
    s_add_u32 s13, s13, 4096
    s_cmp_eq_u32 s13, 40960
    s_cselect_b32 s13, 0, s13
    s_add_u32 s14, s12, s13
    buffer_load_dwordx4 v[64:67], v4, s[56:59], s14 offen offset:0 sc1
    buffer_load_dwordx4 v[68:71], v6, s[56:59], s14 offen offset:0 sc1
    buffer_load_dwordx4 v[72:75], v4, s[56:59], s14 offen offset:2048 sc1
    buffer_load_dwordx4 v[76:79], v6, s[56:59], s14 offen offset:2048 sc1
    s_add_u32 s13, s13, 4096
    s_cmp_eq_u32 s13, 40960
    s_cselect_b32 s13, 0, s13
    s_waitcnt vmcnt(14)
    v_mfma_f32_16x16x32_bf16 v[200:203], v[80:83], v[16:19], 0
    v_mfma_f32_16x16x32_bf16 v[220:223], v[80:83], v[20:23], 0
    v_mfma_f32_16x16x32_bf16 v[204:207], v[84:87], v[16:19], 0
    v_mfma_f32_16x16x32_bf16 v[224:227], v[84:87], v[20:23], 0
    v_mfma_f32_16x16x32_bf16 v[208:211], v[88:91], v[16:19], 0
    v_mfma_f32_16x16x32_bf16 v[228:231], v[88:91], v[20:23], 0
    v_mfma_f32_16x16x32_bf16 v[212:215], v[92:95], v[16:19], 0
    v_mfma_f32_16x16x32_bf16 v[232:235], v[92:95], v[20:23], 0
    v_mfma_f32_16x16x32_bf16 v[216:219], v[96:99], v[16:19], 0
    v_mfma_f32_16x16x32_bf16 v[236:239], v[96:99], v[20:23], 0
    ds_read_b128 v[80:83], v9 offset:0
    ds_read_b128 v[84:87], v9 offset:2048
    ds_read_b128 v[88:91], v9 offset:4096
    ds_read_b128 v[92:95], v9 offset:6144
    ds_read_b128 v[96:99], v9 offset:8192
    s_waitcnt vmcnt(12)
    v_mfma_f32_16x16x32_bf16 v[200:203], v[100:103], v[24:27], v[200:203]
    v_mfma_f32_16x16x32_bf16 v[220:223], v[100:103], v[28:31], v[220:223]
    v_mfma_f32_16x16x32_bf16 v[204:207], v[104:107], v[24:27], v[204:207]
    v_mfma_f32_16x16x32_bf16 v[224:227], v[104:107], v[28:31], v[224:227]
    v_mfma_f32_16x16x32_bf16 v[208:211], v[108:111], v[24:27], v[208:211]
    v_mfma_f32_16x16x32_bf16 v[228:231], v[108:111], v[28:31], v[228:231]
    v_mfma_f32_16x16x32_bf16 v[212:215], v[112:115], v[24:27], v[212:215]
    v_mfma_f32_16x16x32_bf16 v[232:235], v[112:115], v[28:31], v[232:235]
    v_mfma_f32_16x16x32_bf16 v[216:219], v[116:119], v[24:27], v[216:219]
    v_mfma_f32_16x16x32_bf16 v[236:239], v[116:119], v[28:31], v[236:239]
    ds_read_b128 v[100:103], v10 offset:0
    ds_read_b128 v[104:107], v10 offset:2048
    ds_read_b128 v[108:111], v10 offset:4096
    ds_read_b128 v[112:115], v10 offset:6144
    ds_read_b128 v[116:119], v10 offset:8192
    s_add_u32 s14, s12, s13
    buffer_load_dwordx4 v[16:19], v4, s[56:59], s14 offen offset:0 sc1
    buffer_load_dwordx4 v[20:23], v6, s[56:59], s14 offen offset:0 sc1
    buffer_load_dwordx4 v[24:27], v4, s[56:59], s14 offen offset:2048 sc1
    buffer_load_dwordx4 v[28:31], v6, s[56:59], s14 offen offset:2048 sc1
    s_add_u32 s13, s13, 4096
    s_cmp_eq_u32 s13, 40960
    s_cselect_b32 s13, 0, s13
    s_waitcnt vmcnt(14)
    v_mfma_f32_16x16x32_bf16 v[200:203], v[120:123], v[32:35], v[200:203]
    v_mfma_f32_16x16x32_bf16 v[220:223], v[120:123], v[36:39], v[220:223]
    v_mfma_f32_16x16x32_bf16 v[204:207], v[124:127], v[32:35], v[204:207]
    v_mfma_f32_16x16x32_bf16 v[224:227], v[124:127], v[36:39], v[224:227]
    v_mfma_f32_16x16x32_bf16 v[208:211], v[128:131], v[32:35], v[208:211]
    v_mfma_f32_16x16x32_bf16 v[228:231], v[128:131], v[36:39], v[228:231]
    v_mfma_f32_16x16x32_bf16 v[212:215], v[132:135], v[32:35], v[212:215]
    v_mfma_f32_16x16x32_bf16 v[232:235], v[132:135], v[36:39], v[232:235]
    v_mfma_f32_16x16x32_bf16 v[216:219], v[136:139], v[32:35], v[216:219]
    v_mfma_f32_16x16x32_bf16 v[236:239], v[136:139], v[36:39], v[236:239]
    v_mov_b32 v250, 159440
    s_mov_b32 s15, 0x800000
L_lw16:
    ds_read_b32 v251, v250
    s_waitcnt lgkmcnt(0)
    v_readfirstlane_b32 s0, v251
    s_cmp_ge_u32 s0, 4
    s_cbranch_scc1 L_lw16_ok
    s_sub_u32 s15, s15, 1
    s_cbranch_scc0 L_lw16
L_lw16_ok:
    s_waitcnt lgkmcnt(10)
    ds_read_b128 v[120:123], v9 offset:20480
    ds_read_b128 v[124:127], v9 offset:22528
    ds_read_b128 v[128:131], v9 offset:24576
    ds_read_b128 v[132:135], v9 offset:26624
    ds_read_b128 v[136:139], v9 offset:28672
    s_waitcnt vmcnt(12)
    v_mfma_f32_16x16x32_bf16 v[200:203], v[140:143], v[40:43], v[200:203]
    v_mfma_f32_16x16x32_bf16 v[220:223], v[140:143], v[44:47], v[220:223]
    v_mfma_f32_16x16x32_bf16 v[204:207], v[144:147], v[40:43], v[204:207]
    v_mfma_f32_16x16x32_bf16 v[224:227], v[144:147], v[44:47], v[224:227]
    v_mfma_f32_16x16x32_bf16 v[208:211], v[148:151], v[40:43], v[208:211]
    v_mfma_f32_16x16x32_bf16 v[228:231], v[148:151], v[44:47], v[228:231]
    v_mfma_f32_16x16x32_bf16 v[212:215], v[152:155], v[40:43], v[212:215]
    v_mfma_f32_16x16x32_bf16 v[232:235], v[152:155], v[44:47], v[232:235]
    v_mfma_f32_16x16x32_bf16 v[216:219], v[156:159], v[40:43], v[216:219]
    v_mfma_f32_16x16x32_bf16 v[236:239], v[156:159], v[44:47], v[236:239]
    s_waitcnt lgkmcnt(10)
    ds_read_b128 v[140:143], v10 offset:20480
    ds_read_b128 v[144:147], v10 offset:22528
    ds_read_b128 v[148:151], v10 offset:24576
    ds_read_b128 v[152:155], v10 offset:26624
    ds_read_b128 v[156:159], v10 offset:28672
    s_add_u32 s14, s12, s13
    buffer_load_dwordx4 v[32:35], v4, s[56:59], s14 offen offset:0 sc1
    buffer_load_dwordx4 v[36:39], v6, s[56:59], s14 offen offset:0 sc1
    buffer_load_dwordx4 v[40:43], v4, s[56:59], s14 offen offset:2048 sc1
    buffer_load_dwordx4 v[44:47], v6, s[56:59], s14 offen offset:2048 sc1
    s_add_u32 s13, s13, 4096
    s_cmp_eq_u32 s13, 40960
    s_cselect_b32 s13, 0, s13
    s_waitcnt vmcnt(14)
    v_mfma_f32_16x16x32_bf16 v[200:203], v[160:163], v[48:51], v[200:203]
    v_mfma_f32_16x16x32_bf16 v[220:223], v[160:163], v[52:55], v[220:223]
    v_mfma_f32_16x16x32_bf16 v[204:207], v[164:167], v[48:51], v[204:207]
    v_mfma_f32_16x16x32_bf16 v[224:227], v[164:167], v[52:55], v[224:227]
    v_mfma_f32_16x16x32_bf16 v[208:211], v[168:171], v[48:51], v[208:211]
    v_mfma_f32_16x16x32_bf16 v[228:231], v[168:171], v[52:55], v[228:231]
    v_mfma_f32_16x16x32_bf16 v[212:215], v[172:175], v[48:51], v[212:215]
    v_mfma_f32_16x16x32_bf16 v[232:235], v[172:175], v[52:55], v[232:235]
    v_mfma_f32_16x16x32_bf16 v[216:219], v[176:179], v[48:51], v[216:219]
    v_mfma_f32_16x16x32_bf16 v[236:239], v[176:179], v[52:55], v[236:239]
    s_waitcnt lgkmcnt(10)
    ds_read_b128 v[160:163], v9 offset:40960
    ds_read_b128 v[164:167], v9 offset:43008
    ds_read_b128 v[168:171], v9 offset:45056
    ds_read_b128 v[172:175], v9 offset:47104
    ds_read_b128 v[176:179], v9 offset:49152
    s_waitcnt vmcnt(12)
    v_mfma_f32_16x16x32_bf16 v[200:203], v[180:183], v[56:59], v[200:203]
    v_mfma_f32_16x16x32_bf16 v[220:223], v[180:183], v[60:63], v[220:223]
    v_mfma_f32_16x16x32_bf16 v[204:207], v[184:187], v[56:59], v[204:207]
    v_mfma_f32_16x16x32_bf16 v[224:227], v[184:187], v[60:63], v[224:227]
    v_mfma_f32_16x16x32_bf16 v[208:211], v[188:191], v[56:59], v[208:211]
    v_mfma_f32_16x16x32_bf16 v[228:231], v[188:191], v[60:63], v[228:231]
    v_mfma_f32_16x16x32_bf16 v[212:215], v[192:195], v[56:59], v[212:215]
    v_mfma_f32_16x16x32_bf16 v[232:235], v[192:195], v[60:63], v[232:235]
    v_mfma_f32_16x16x32_bf16 v[216:219], v[196:199], v[56:59], v[216:219]
    v_mfma_f32_16x16x32_bf16 v[236:239], v[196:199], v[60:63], v[236:239]
    s_waitcnt lgkmcnt(10)
    ds_read_b128 v[180:183], v10 offset:40960
    ds_read_b128 v[184:187], v10 offset:43008
    ds_read_b128 v[188:191], v10 offset:45056
    ds_read_b128 v[192:195], v10 offset:47104
    ds_read_b128 v[196:199], v10 offset:49152
    s_add_u32 s14, s12, s13
    buffer_load_dwordx4 v[48:51], v4, s[56:59], s14 offen offset:0 sc1
    buffer_load_dwordx4 v[52:55], v6, s[56:59], s14 offen offset:0 sc1
    buffer_load_dwordx4 v[56:59], v4, s[56:59], s14 offen offset:2048 sc1
    buffer_load_dwordx4 v[60:63], v6, s[56:59], s14 offen offset:2048 sc1
    s_add_u32 s13, s13, 4096
    s_cmp_eq_u32 s13, 40960
    s_cselect_b32 s13, 0, s13
    s_waitcnt vmcnt(14)
    s_waitcnt lgkmcnt(10)
    v_mfma_f32_16x16x32_bf16 v[200:203], v[80:83], v[64:67], v[200:203]
    v_mfma_f32_16x16x32_bf16 v[220:223], v[80:83], v[68:71], v[220:223]
    v_mfma_f32_16x16x32_bf16 v[204:207], v[84:87], v[64:67], v[204:207]
    v_mfma_f32_16x16x32_bf16 v[224:227], v[84:87], v[68:71], v[224:227]
    v_mfma_f32_16x16x32_bf16 v[208:211], v[88:91], v[64:67], v[208:211]
    v_mfma_f32_16x16x32_bf16 v[228:231], v[88:91], v[68:71], v[228:231]
    v_mfma_f32_16x16x32_bf16 v[212:215], v[92:95], v[64:67], v[212:215]
    v_mfma_f32_16x16x32_bf16 v[232:235], v[92:95], v[68:71], v[232:235]
    v_mfma_f32_16x16x32_bf16 v[216:219], v[96:99], v[64:67], v[216:219]
    v_mfma_f32_16x16x32_bf16 v[236:239], v[96:99], v[68:71], v[236:239]
    ds_read_b128 v[80:83], v11 offset:0
    ds_read_b128 v[84:87], v11 offset:2048
    ds_read_b128 v[88:91], v11 offset:4096
    ds_read_b128 v[92:95], v11 offset:6144
    ds_read_b128 v[96:99], v11 offset:8192
    s_waitcnt vmcnt(12)
    s_waitcnt lgkmcnt(10)
    v_mfma_f32_16x16x32_bf16 v[200:203], v[100:103], v[72:75], v[200:203]
    v_mfma_f32_16x16x32_bf16 v[220:223], v[100:103], v[76:79], v[220:223]
    v_mfma_f32_16x16x32_bf16 v[204:207], v[104:107], v[72:75], v[204:207]
    v_mfma_f32_16x16x32_bf16 v[224:227], v[104:107], v[76:79], v[224:227]
    v_mfma_f32_16x16x32_bf16 v[208:211], v[108:111], v[72:75], v[208:211]
    v_mfma_f32_16x16x32_bf16 v[228:231], v[108:111], v[76:79], v[228:231]
    v_mfma_f32_16x16x32_bf16 v[212:215], v[112:115], v[72:75], v[212:215]
    v_mfma_f32_16x16x32_bf16 v[232:235], v[112:115], v[76:79], v[232:235]
    v_mfma_f32_16x16x32_bf16 v[216:219], v[116:119], v[72:75], v[216:219]
    v_mfma_f32_16x16x32_bf16 v[236:239], v[116:119], v[76:79], v[236:239]
    ds_read_b128 v[100:103], v12 offset:0
    ds_read_b128 v[104:107], v12 offset:2048
    ds_read_b128 v[108:111], v12 offset:4096
    ds_read_b128 v[112:115], v12 offset:6144
    ds_read_b128 v[116:119], v12 offset:8192
    s_add_u32 s14, s12, s13
    buffer_load_dwordx4 v[64:67], v4, s[56:59], s14 offen offset:0 sc1
    buffer_load_dwordx4 v[68:71], v6, s[56:59], s14 offen offset:0 sc1
    buffer_load_dwordx4 v[72:75], v4, s[56:59], s14 offen offset:2048 sc1
    buffer_load_dwordx4 v[76:79], v6, s[56:59], s14 offen offset:2048 sc1
    s_add_u32 s13, s13, 4096
    s_cmp_eq_u32 s13, 40960
    s_cselect_b32 s13, 0, s13
    s_waitcnt vmcnt(14)
    s_waitcnt lgkmcnt(10)
    v_mfma_f32_16x16x32_bf16 v[200:203], v[120:123], v[16:19], v[200:203]
    v_mfma_f32_16x16x32_bf16 v[220:223], v[120:123], v[20:23], v[220:223]
    v_mfma_f32_16x16x32_bf16 v[204:207], v[124:127], v[16:19], v[204:207]
    v_mfma_f32_16x16x32_bf16 v[224:227], v[124:127], v[20:23], v[224:227]
    v_mfma_f32_16x16x32_bf16 v[208:211], v[128:131], v[16:19], v[208:211]
    v_mfma_f32_16x16x32_bf16 v[228:231], v[128:131], v[20:23], v[228:231]
    v_mfma_f32_16x16x32_bf16 v[212:215], v[132:135], v[16:19], v[212:215]
    v_mfma_f32_16x16x32_bf16 v[232:235], v[132:135], v[20:23], v[232:235]
    v_mfma_f32_16x16x32_bf16 v[216:219], v[136:139], v[16:19], v[216:219]
    v_mfma_f32_16x16x32_bf16 v[236:239], v[136:139], v[20:23], v[236:239]
    v_mov_b32 v250, 159588
    s_mov_b32 s15, 0x800000
L_lw17:
    ds_read_b32 v251, v250
    s_waitcnt lgkmcnt(0)
    v_readfirstlane_b32 s0, v251
    s_cmp_ge_u32 s0, 4
    s_cbranch_scc1 L_lw17_ok
    s_sub_u32 s15, s15, 1
    s_cbranch_scc0 L_lw17
L_lw17_ok:
    v_mov_b32 v250, 159592
    v_mov_b32 v251, 1
    s_mov_b64 exec, 1
    ds_add_u32 v250, v251
    s_mov_b64 exec, -1
    ds_read_b128 v[120:123], v7 offset:0
    ds_read_b128 v[124:127], v7 offset:2048
    ds_read_b128 v[128:131], v7 offset:4096
    ds_read_b128 v[132:135], v7 offset:6144
    ds_read_b128 v[136:139], v7 offset:8192
    s_waitcnt vmcnt(12)
    s_waitcnt lgkmcnt(10)
    v_mfma_f32_16x16x32_bf16 v[200:203], v[140:143], v[24:27], v[200:203]
    v_mfma_f32_16x16x32_bf16 v[220:223], v[140:143], v[28:31], v[220:223]
    v_mfma_f32_16x16x32_bf16 v[204:207], v[144:147], v[24:27], v[204:207]
    v_mfma_f32_16x16x32_bf16 v[224:227], v[144:147], v[28:31], v[224:227]
    v_mfma_f32_16x16x32_bf16 v[208:211], v[148:151], v[24:27], v[208:211]
    v_mfma_f32_16x16x32_bf16 v[228:231], v[148:151], v[28:31], v[228:231]
    v_mfma_f32_16x16x32_bf16 v[212:215], v[152:155], v[24:27], v[212:215]
    v_mfma_f32_16x16x32_bf16 v[232:235], v[152:155], v[28:31], v[232:235]
    v_mfma_f32_16x16x32_bf16 v[216:219], v[156:159], v[24:27], v[216:219]
    v_mfma_f32_16x16x32_bf16 v[236:239], v[156:159], v[28:31], v[236:239]
    ds_read_b128 v[140:143], v8 offset:0
    ds_read_b128 v[144:147], v8 offset:2048
    ds_read_b128 v[148:151], v8 offset:4096
    ds_read_b128 v[152:155], v8 offset:6144
    ds_read_b128 v[156:159], v8 offset:8192
    s_add_u32 s14, s12, s13
    buffer_load_dwordx4 v[16:19], v4, s[56:59], s14 offen offset:0 sc1
    buffer_load_dwordx4 v[20:23], v6, s[56:59], s14 offen offset:0 sc1
    buffer_load_dwordx4 v[24:27], v4, s[56:59], s14 offen offset:2048 sc1
    buffer_load_dwordx4 v[28:31], v6, s[56:59], s14 offen offset:2048 sc1
    s_add_u32 s13, s13, 4096
    s_cmp_eq_u32 s13, 40960
    s_cselect_b32 s13, 0, s13
    s_waitcnt vmcnt(14)
    s_waitcnt lgkmcnt(10)
    v_mfma_f32_16x16x32_bf16 v[200:203], v[160:163], v[32:35], v[200:203]
    v_mfma_f32_16x16x32_bf16 v[220:223], v[160:163], v[36:39], v[220:223]
    v_mfma_f32_16x16x32_bf16 v[204:207], v[164:167], v[32:35], v[204:207]
    v_mfma_f32_16x16x32_bf16 v[224:227], v[164:167], v[36:39], v[224:227]
    v_mfma_f32_16x16x32_bf16 v[208:211], v[168:171], v[32:35], v[208:211]
    v_mfma_f32_16x16x32_bf16 v[228:231], v[168:171], v[36:39], v[228:231]
    v_mfma_f32_16x16x32_bf16 v[212:215], v[172:175], v[32:35], v[212:215]
    v_mfma_f32_16x16x32_bf16 v[232:235], v[172:175], v[36:39], v[232:235]
    v_mfma_f32_16x16x32_bf16 v[216:219], v[176:179], v[32:35], v[216:219]
    v_mfma_f32_16x16x32_bf16 v[236:239], v[176:179], v[36:39], v[236:239]
    ds_read_b128 v[160:163], v7 offset:20480
    ds_read_b128 v[164:167], v7 offset:22528
    ds_read_b128 v[168:171], v7 offset:24576
    ds_read_b128 v[172:175], v7 offset:26624
    ds_read_b128 v[176:179], v7 offset:28672
    s_waitcnt vmcnt(12)
    s_waitcnt lgkmcnt(10)
    v_mfma_f32_16x16x32_bf16 v[200:203], v[180:183], v[40:43], v[200:203]
    v_mfma_f32_16x16x32_bf16 v[220:223], v[180:183], v[44:47], v[220:223]
    v_mfma_f32_16x16x32_bf16 v[204:207], v[184:187], v[40:43], v[204:207]
    v_mfma_f32_16x16x32_bf16 v[224:227], v[184:187], v[44:47], v[224:227]
    v_mfma_f32_16x16x32_bf16 v[208:211], v[188:191], v[40:43], v[208:211]
    v_mfma_f32_16x16x32_bf16 v[228:231], v[188:191], v[44:47], v[228:231]
    v_mfma_f32_16x16x32_bf16 v[212:215], v[192:195], v[40:43], v[212:215]
    v_mfma_f32_16x16x32_bf16 v[232:235], v[192:195], v[44:47], v[232:235]
    v_mfma_f32_16x16x32_bf16 v[216:219], v[196:199], v[40:43], v[216:219]
    v_mfma_f32_16x16x32_bf16 v[236:239], v[196:199], v[44:47], v[236:239]
    ds_read_b128 v[180:183], v8 offset:20480
    ds_read_b128 v[184:187], v8 offset:22528
    ds_read_b128 v[188:191], v8 offset:24576
    ds_read_b128 v[192:195], v8 offset:26624
    ds_read_b128 v[196:199], v8 offset:28672
    s_add_u32 s14, s12, s13
    buffer_load_dwordx4 v[32:35], v4, s[56:59], s14 offen offset:0 sc1
    buffer_load_dwordx4 v[36:39], v6, s[56:59], s14 offen offset:0 sc1
    buffer_load_dwordx4 v[40:43], v4, s[56:59], s14 offen offset:2048 sc1
    buffer_load_dwordx4 v[44:47], v6, s[56:59], s14 offen offset:2048 sc1
    s_add_u32 s13, s13, 4096
    s_cmp_eq_u32 s13, 40960
    s_cselect_b32 s13, 0, s13
    s_waitcnt vmcnt(14)
    s_waitcnt lgkmcnt(10)
    v_mfma_f32_16x16x32_bf16 v[200:203], v[80:83], v[48:51], v[200:203]
    v_mfma_f32_16x16x32_bf16 v[220:223], v[80:83], v[52:55], v[220:223]
    v_mfma_f32_16x16x32_bf16 v[204:207], v[84:87], v[48:51], v[204:207]
    v_mfma_f32_16x16x32_bf16 v[224:227], v[84:87], v[52:55], v[224:227]
    v_mfma_f32_16x16x32_bf16 v[208:211], v[88:91], v[48:51], v[208:211]
    v_mfma_f32_16x16x32_bf16 v[228:231], v[88:91], v[52:55], v[228:231]
    v_mfma_f32_16x16x32_bf16 v[212:215], v[92:95], v[48:51], v[212:215]
    v_mfma_f32_16x16x32_bf16 v[232:235], v[92:95], v[52:55], v[232:235]
    v_mfma_f32_16x16x32_bf16 v[216:219], v[96:99], v[48:51], v[216:219]
    v_mfma_f32_16x16x32_bf16 v[236:239], v[96:99], v[52:55], v[236:239]
    ds_read_b128 v[80:83], v7 offset:40960
    ds_read_b128 v[84:87], v7 offset:43008
    ds_read_b128 v[88:91], v7 offset:45056
    ds_read_b128 v[92:95], v7 offset:47104
    ds_read_b128 v[96:99], v7 offset:49152
    s_waitcnt vmcnt(12)
    s_waitcnt lgkmcnt(10)
    v_mfma_f32_16x16x32_bf16 v[200:203], v[100:103], v[56:59], v[200:203]
    v_mfma_f32_16x16x32_bf16 v[220:223], v[100:103], v[60:63], v[220:223]
    v_mfma_f32_16x16x32_bf16 v[204:207], v[104:107], v[56:59], v[204:207]
    v_mfma_f32_16x16x32_bf16 v[224:227], v[104:107], v[60:63], v[224:227]
    v_mfma_f32_16x16x32_bf16 v[208:211], v[108:111], v[56:59], v[208:211]
    v_mfma_f32_16x16x32_bf16 v[228:231], v[108:111], v[60:63], v[228:231]
    v_mfma_f32_16x16x32_bf16 v[212:215], v[112:115], v[56:59], v[212:215]
    v_mfma_f32_16x16x32_bf16 v[232:235], v[112:115], v[60:63], v[232:235]
    v_mfma_f32_16x16x32_bf16 v[216:219], v[116:119], v[56:59], v[216:219]
    v_mfma_f32_16x16x32_bf16 v[236:239], v[116:119], v[60:63], v[236:239]
    ds_read_b128 v[100:103], v8 offset:40960
    ds_read_b128 v[104:107], v8 offset:43008
    ds_read_b128 v[108:111], v8 offset:45056
    ds_read_b128 v[112:115], v8 offset:47104
    ds_read_b128 v[116:119], v8 offset:49152
    s_waitcnt vmcnt(10)
    s_waitcnt lgkmcnt(10)
    v_mfma_f32_16x16x32_bf16 v[200:203], v[120:123], v[64:67], v[200:203]
    v_mfma_f32_16x16x32_bf16 v[220:223], v[120:123], v[68:71], v[220:223]
    v_mfma_f32_16x16x32_bf16 v[204:207], v[124:127], v[64:67], v[204:207]
    v_mfma_f32_16x16x32_bf16 v[224:227], v[124:127], v[68:71], v[224:227]
    v_mfma_f32_16x16x32_bf16 v[208:211], v[128:131], v[64:67], v[208:211]
    v_mfma_f32_16x16x32_bf16 v[228:231], v[128:131], v[68:71], v[228:231]
    v_mfma_f32_16x16x32_bf16 v[212:215], v[132:135], v[64:67], v[212:215]
    v_mfma_f32_16x16x32_bf16 v[232:235], v[132:135], v[68:71], v[232:235]
    v_mfma_f32_16x16x32_bf16 v[216:219], v[136:139], v[64:67], v[216:219]
    v_mfma_f32_16x16x32_bf16 v[236:239], v[136:139], v[68:71], v[236:239]
    s_waitcnt vmcnt(8)
    s_waitcnt lgkmcnt(10)
    v_mfma_f32_16x16x32_bf16 v[200:203], v[140:143], v[72:75], v[200:203]
    v_mfma_f32_16x16x32_bf16 v[220:223], v[140:143], v[76:79], v[220:223]
    v_mfma_f32_16x16x32_bf16 v[204:207], v[144:147], v[72:75], v[204:207]
    v_mfma_f32_16x16x32_bf16 v[224:227], v[144:147], v[76:79], v[224:227]
    v_mfma_f32_16x16x32_bf16 v[208:211], v[148:151], v[72:75], v[208:211]
    v_mfma_f32_16x16x32_bf16 v[228:231], v[148:151], v[76:79], v[228:231]
    v_mfma_f32_16x16x32_bf16 v[212:215], v[152:155], v[72:75], v[212:215]
    v_mfma_f32_16x16x32_bf16 v[232:235], v[152:155], v[76:79], v[232:235]
    v_mfma_f32_16x16x32_bf16 v[216:219], v[156:159], v[72:75], v[216:219]
    v_mfma_f32_16x16x32_bf16 v[236:239], v[156:159], v[76:79], v[236:239]
    s_waitcnt vmcnt(6)
    s_waitcnt lgkmcnt(10)
    v_mfma_f32_16x16x32_bf16 v[200:203], v[160:163], v[16:19], v[200:203]
    v_mfma_f32_16x16x32_bf16 v[220:223], v[160:163], v[20:23], v[220:223]
    v_mfma_f32_16x16x32_bf16 v[204:207], v[164:167], v[16:19], v[204:207]
    v_mfma_f32_16x16x32_bf16 v[224:227], v[164:167], v[20:23], v[224:227]
    v_mfma_f32_16x16x32_bf16 v[208:211], v[168:171], v[16:19], v[208:211]
    v_mfma_f32_16x16x32_bf16 v[228:231], v[168:171], v[20:23], v[228:231]
    v_mfma_f32_16x16x32_bf16 v[212:215], v[172:175], v[16:19], v[212:215]
    v_mfma_f32_16x16x32_bf16 v[232:235], v[172:175], v[20:23], v[232:235]
    v_mfma_f32_16x16x32_bf16 v[216:219], v[176:179], v[16:19], v[216:219]
    v_mfma_f32_16x16x32_bf16 v[236:239], v[176:179], v[20:23], v[236:239]
    s_waitcnt vmcnt(4)
    s_waitcnt lgkmcnt(10)
    v_mfma_f32_16x16x32_bf16 v[200:203], v[180:183], v[24:27], v[200:203]
    v_mfma_f32_16x16x32_bf16 v[220:223], v[180:183], v[28:31], v[220:223]
    v_mfma_f32_16x16x32_bf16 v[204:207], v[184:187], v[24:27], v[204:207]
    v_mfma_f32_16x16x32_bf16 v[224:227], v[184:187], v[28:31], v[224:227]
    v_mfma_f32_16x16x32_bf16 v[208:211], v[188:191], v[24:27], v[208:211]
    v_mfma_f32_16x16x32_bf16 v[228:231], v[188:191], v[28:31], v[228:231]
    v_mfma_f32_16x16x32_bf16 v[212:215], v[192:195], v[24:27], v[212:215]
    v_mfma_f32_16x16x32_bf16 v[232:235], v[192:195], v[28:31], v[232:235]
    v_mfma_f32_16x16x32_bf16 v[216:219], v[196:199], v[24:27], v[216:219]
    v_mfma_f32_16x16x32_bf16 v[236:239], v[196:199], v[28:31], v[236:239]
    s_waitcnt vmcnt(2)
    s_waitcnt lgkmcnt(5)
    v_mfma_f32_16x16x32_bf16 v[200:203], v[80:83], v[32:35], v[200:203]
    v_mfma_f32_16x16x32_bf16 v[220:223], v[80:83], v[36:39], v[220:223]
    v_mfma_f32_16x16x32_bf16 v[204:207], v[84:87], v[32:35], v[204:207]
    v_mfma_f32_16x16x32_bf16 v[224:227], v[84:87], v[36:39], v[224:227]
    v_mfma_f32_16x16x32_bf16 v[208:211], v[88:91], v[32:35], v[208:211]
    v_mfma_f32_16x16x32_bf16 v[228:231], v[88:91], v[36:39], v[228:231]
    v_mfma_f32_16x16x32_bf16 v[212:215], v[92:95], v[32:35], v[212:215]
    v_mfma_f32_16x16x32_bf16 v[232:235], v[92:95], v[36:39], v[232:235]
    v_mfma_f32_16x16x32_bf16 v[216:219], v[96:99], v[32:35], v[216:219]
    v_mfma_f32_16x16x32_bf16 v[236:239], v[96:99], v[36:39], v[236:239]
    s_waitcnt vmcnt(0)
    s_waitcnt lgkmcnt(0)
    v_mfma_f32_16x16x32_bf16 v[200:203], v[100:103], v[40:43], v[200:203]
    v_mfma_f32_16x16x32_bf16 v[220:223], v[100:103], v[44:47], v[220:223]
    v_mfma_f32_16x16x32_bf16 v[204:207], v[104:107], v[40:43], v[204:207]
    v_mfma_f32_16x16x32_bf16 v[224:227], v[104:107], v[44:47], v[224:227]
    v_mfma_f32_16x16x32_bf16 v[208:211], v[108:111], v[40:43], v[208:211]
    v_mfma_f32_16x16x32_bf16 v[228:231], v[108:111], v[44:47], v[228:231]
    v_mfma_f32_16x16x32_bf16 v[212:215], v[112:115], v[40:43], v[212:215]
    v_mfma_f32_16x16x32_bf16 v[232:235], v[112:115], v[44:47], v[232:235]
    v_mfma_f32_16x16x32_bf16 v[216:219], v[116:119], v[40:43], v[216:219]
    v_mfma_f32_16x16x32_bf16 v[236:239], v[116:119], v[44:47], v[236:239]
    v_mov_b32 v250, 159592
    s_mov_b32 s15, 0x800000
L_lw18:
    ds_read_b32 v251, v250
    s_waitcnt lgkmcnt(0)
    v_readfirstlane_b32 s0, v251
    s_cmp_ge_u32 s0, 4
    s_cbranch_scc1 L_lw18_ok
    s_sub_u32 s15, s15, 1
    s_cbranch_scc0 L_lw18
L_lw18_ok:
    v_lshl_add_u32 v10, v3, 2, v2
    v_and_b32 v10, 15, v10
    v_lshlrev_b32 v10, 4, v10
    v_lshl_add_u32 v10, v3, 8, v10
    s_and_b32 s10, s3, 2
    s_lshl1_add_u32 s10, s10, s6
    s_mul_i32 s10, s10, 5120
    s_add_u32 s10, s10, 94208
    v_add_u32 v10, s10, v10
    ds_write_b128 v10, v[200:203] offset:0
    ds_write_b128 v10, v[204:207] offset:1024
    ds_write_b128 v10, v[208:211] offset:2048
    ds_write_b128 v10, v[212:215] offset:3072
    ds_write_b128 v10, v[216:219] offset:4096
    ds_write_b128 v10, v[220:223] offset:10240
    ds_write_b128 v10, v[224:227] offset:11264
    ds_write_b128 v10, v[228:231] offset:12288
    ds_write_b128 v10, v[232:235] offset:13312
    ds_write_b128 v10, v[236:239] offset:14336
    v_lshrrev_b32 v2, 2, v0
    v_and_b32 v3, 3, v0
    v_lshl_add_u32 v7, v3, 2, v2
    v_and_b32 v7, 15, v7
    v_lshlrev_b32 v7, 4, v7
    v_lshl_add_u32 v7, v3, 8, v7
    v_xor_b32 v3, 3, v3
    v_lshl_add_u32 v8, v3, 2, v2
    v_and_b32 v8, 15, v8
    v_lshlrev_b32 v8, 4, v8
    v_lshl_add_u32 v8, v3, 8, v8
    s_mul_i32 s10, s3, 10240
    s_add_u32 s10, s10, 94208
    v_add_u32 v12, s10, v7
    s_lshl_b32 s10, s3, 11
    s_add_u32 s10, s10, 61440
    v_add_u32 v7, s10, v7
    v_add_u32 v8, s10, v8
    s_bitcmp1_b32 s66, 0
    s_cselect_b32 s10, -1.0, 1.0
    s_mov_b32 s11, s10
    s_cselect_b64 vcc, -1, 0
    v_cndmask_b32 v9, v7, v8, vcc
    s_add_u32 s12, s66, 1
    s_bitcmp1_b32 s12, 1
    s_cselect_b32 s12, 1.0, -1.0
    s_mov_b32 s13, s12
    v_lshl_add_u32 v11, s3, 4, v2
    v_lshlrev_b32 v11, 2, v11
    v_add_u32 v11, 159744, v11
    s_mov_b32 s48, s42
    s_mov_b32 s49, s43
    s_mov_b32 s50, 5242880
    s_mov_b32 s51, 0x20000
    v_lshlrev_b32 v13, 1, v13
    s_mov_b32 s14, 0xffff0000
    v_lshlrev_b32 v180, 16, v240
    v_and_b32 v181, s14, v240
    v_lshlrev_b32 v182, 16, v241
    v_and_b32 v183, s14, v241
    v_lshlrev_b32 v184, 16, v242
    v_and_b32 v185, s14, v242
    v_lshlrev_b32 v186, 16, v243
    v_and_b32 v187, s14, v243
    v_lshlrev_b32 v188, 16, v244
    v_and_b32 v189, s14, v244
    v_lshlrev_b32 v190, 16, v245
    v_and_b32 v191, s14, v245
    v_lshlrev_b32 v192, 16, v246
    v_and_b32 v193, s14, v246
    v_lshlrev_b32 v194, 16, v247
    v_and_b32 v195, s14, v247
    v_lshlrev_b32 v196, 16, v248
    v_and_b32 v197, s14, v248
    v_lshlrev_b32 v198, 16, v249
    v_and_b32 v199, s14, v249
    s_waitcnt lgkmcnt(0)
    s_barrier
    ds_read_b32 v250, v11
    ds_read_b128 v[140:143], v12 offset:0
    ds_read_b128 v[144:147], v12 offset:1024
    ds_read_b128 v[148:151], v12 offset:2048
    ds_read_b128 v[152:155], v12 offset:3072
    ds_read_b128 v[156:159], v12 offset:4096
    ds_read_b128 v[160:163], v12 offset:5120
    ds_read_b128 v[164:167], v12 offset:6144
    ds_read_b128 v[168:171], v12 offset:7168
    ds_read_b128 v[172:175], v12 offset:8192
    ds_read_b128 v[176:179], v12 offset:9216
    ds_read_b128 v[80:83], v7 offset:0
    ds_read_b128 v[84:87], v7 offset:8192
    ds_read_b128 v[88:91], v7 offset:16384
    ds_read_b128 v[92:95], v7 offset:24576
    s_waitcnt lgkmcnt(9)
    ds_read_b128 v[100:103], v8 offset:0
    ds_read_b128 v[104:107], v8 offset:8192
    ds_read_b128 v[108:111], v8 offset:16384
    ds_read_b128 v[112:115], v8 offset:24576
    v_pk_add_f32 v[180:181], v[180:181], v[140:141]
    v_pk_add_f32 v[182:183], v[182:183], v[142:143]
    v_pk_add_f32 v[184:185], v[184:185], v[144:145]
    v_pk_add_f32 v[186:187], v[186:187], v[146:147]
    v_pk_add_f32 v[188:189], v[188:189], v[148:149]
    v_pk_add_f32 v[190:191], v[190:191], v[150:151]
    v_pk_add_f32 v[192:193], v[192:193], v[152:153]
    v_pk_add_f32 v[194:195], v[194:195], v[154:155]
    v_pk_add_f32 v[196:197], v[196:197], v[156:157]
    v_pk_add_f32 v[198:199], v[198:199], v[158:159]
    s_waitcnt lgkmcnt(8)
    ds_read_b128 v[120:123], v9 offset:1024
    ds_read_b128 v[124:127], v9 offset:9216
    ds_read_b128 v[128:131], v9 offset:17408
    ds_read_b128 v[132:135], v9 offset:25600
    v_pk_add_f32 v[180:181], v[180:181], v[160:161]
    v_pk_add_f32 v[182:183], v[182:183], v[162:163]
    v_pk_add_f32 v[184:185], v[184:185], v[164:165]
    v_pk_add_f32 v[186:187], v[186:187], v[166:167]
    v_pk_add_f32 v[188:189], v[188:189], v[168:169]
    v_pk_add_f32 v[190:191], v[190:191], v[170:171]
    v_pk_add_f32 v[192:193], v[192:193], v[172:173]
    v_pk_add_f32 v[194:195], v[194:195], v[174:175]
    v_pk_add_f32 v[196:197], v[196:197], v[176:177]
    v_pk_add_f32 v[198:199], v[198:199], v[178:179]
    s_waitcnt lgkmcnt(8)
    v_pk_add_f32 v[80:81], v[80:81], v[88:89]
    v_pk_add_f32 v[84:85], v[84:85], v[92:93]
    v_pk_add_f32 v[82:83], v[82:83], v[90:91]
    v_pk_add_f32 v[86:87], v[86:87], v[94:95]
    v_pk_add_f32 v[88:89], v[80:81], v[84:85]
    v_pk_add_f32 v[92:93], v[80:81], v[84:85] neg_lo:[0,1] neg_hi:[0,1]
    v_pk_add_f32 v[90:91], v[82:83], v[86:87]
    v_pk_add_f32 v[94:95], v[82:83], v[86:87] neg_lo:[0,1] neg_hi:[0,1]
    v_pk_fma_f32 v[188:189], v[188:189], v[250:251], v[88:89] op_sel_hi:[1,0,1]
    v_pk_fma_f32 v[190:191], v[190:191], v[250:251], v[90:91] op_sel_hi:[1,0,1]
    s_lshl_b32 s14, s62, 2
    buffer_store_dwordx4 v[188:191], v13, s[48:51], s14 offen
    v_pk_fma_f32 v[180:181], v[180:181], v[250:251], v[92:93] op_sel_hi:[1,0,1]
    v_pk_fma_f32 v[182:183], v[182:183], v[250:251], v[94:95] op_sel_hi:[1,0,1]
    s_lshl_b32 s14, s60, 2
    buffer_store_dwordx4 v[180:183], v13, s[48:51], s14 offen
    s_waitcnt lgkmcnt(4)
    v_pk_add_f32 v[100:101], v[100:101], v[108:109] neg_lo:[0,1] neg_hi:[0,1]
    v_pk_add_f32 v[104:105], v[104:105], v[112:113] neg_lo:[0,1] neg_hi:[0,1]
    v_pk_add_f32 v[102:103], v[102:103], v[110:111] neg_lo:[0,1] neg_hi:[0,1]
    v_pk_add_f32 v[106:107], v[106:107], v[114:115] neg_lo:[0,1] neg_hi:[0,1]
    v_pk_add_f32 v[108:109], v[100:101], v[104:105]
    v_pk_add_f32 v[112:113], v[100:101], v[104:105] neg_lo:[0,1] neg_hi:[0,1]
    v_pk_add_f32 v[110:111], v[102:103], v[106:107]
    v_pk_add_f32 v[114:115], v[102:103], v[106:107] neg_lo:[0,1] neg_hi:[0,1]
    v_pk_fma_f32 v[184:185], v[184:185], v[250:251], v[110:111] op_sel:[0,0,1] op_sel_hi:[1,0,0]
    v_pk_fma_f32 v[186:187], v[186:187], v[250:251], v[108:109] op_sel:[0,0,1] op_sel_hi:[1,0,0]
    s_lshl_b32 s14, s61, 2
    buffer_store_dwordx4 v[184:187], v13, s[48:51], s14 offen
    v_pk_fma_f32 v[192:193], v[192:193], v[250:251], v[114:115] op_sel:[0,0,1] op_sel_hi:[1,0,0]
    v_pk_fma_f32 v[194:195], v[194:195], v[250:251], v[112:113] op_sel:[0,0,1] op_sel_hi:[1,0,0]
    s_lshl_b32 s14, s63, 2
    buffer_store_dwordx4 v[192:195], v13, s[48:51], s14 offen
    s_waitcnt lgkmcnt(0)
    v_pk_fma_f32 v[120:121], v[128:129], s[10:11], v[120:121]
    v_pk_fma_f32 v[124:125], v[132:133], s[10:11], v[124:125]
    v_pk_fma_f32 v[122:123], v[130:131], s[10:11], v[122:123]
    v_pk_fma_f32 v[126:127], v[134:135], s[10:11], v[126:127]
    v_pk_fma_f32 v[120:121], v[124:125], s[12:13], v[120:121]
    v_pk_fma_f32 v[122:123], v[126:127], s[12:13], v[122:123]
    v_cndmask_b32 v124, v120, v123, vcc
    v_cndmask_b32 v125, v121, v122, vcc
    v_cndmask_b32 v126, v122, v121, vcc
    v_cndmask_b32 v127, v123, v120, vcc
    v_pk_fma_f32 v[196:197], v[196:197], v[250:251], v[124:125] op_sel_hi:[1,0,1]
    v_pk_fma_f32 v[198:199], v[198:199], v[250:251], v[126:127] op_sel_hi:[1,0,1]
    s_lshl_b32 s14, s64, 2
    buffer_store_dwordx4 v[196:199], v13, s[48:51], s14 offen
    s_endpgm
L_P3l:
    s_sub_u32 s6, s3, 4
    s_add_u32 m0, s70, 0
    s_nop 0
    buffer_load_dwordx4 v250, s[72:75], s69 offen lds
    s_add_u32 m0, s70, 1024
    s_nop 0
    buffer_load_dwordx4 v251, s[72:75], s69 offen lds
    s_add_u32 m0, s70, 2048
    s_nop 0
    buffer_load_dwordx4 v252, s[72:75], s69 offen lds
    s_add_u32 m0, s70, 3072
    s_nop 0
    buffer_load_dwordx4 v253, s[72:75], s69 offen lds
    s_add_u32 m0, s70, 4096
    s_nop 0
    buffer_load_dwordx4 v254, s[72:75], s69 offen lds
    s_add_u32 s69, s69, 128
    s_cmp_eq_u32 s69, 1280
    s_cselect_b32 s69, 0, s69
    s_add_u32 m0, s70, 20480
    s_nop 0
    buffer_load_dwordx4 v250, s[72:75], s69 offen lds
    s_add_u32 m0, s70, 21504
    s_nop 0
    buffer_load_dwordx4 v251, s[72:75], s69 offen lds
    s_add_u32 m0, s70, 22528
    s_nop 0
    buffer_load_dwordx4 v252, s[72:75], s69 offen lds
    s_add_u32 m0, s70, 23552
    s_nop 0
    buffer_load_dwordx4 v253, s[72:75], s69 offen lds
    s_add_u32 m0, s70, 24576
    s_nop 0
    buffer_load_dwordx4 v254, s[72:75], s69 offen lds
    s_add_u32 s69, s69, 128
    s_cmp_eq_u32 s69, 1280
    s_cselect_b32 s69, 0, s69
    s_add_u32 m0, s70, 40960
    s_nop 0
    buffer_load_dwordx4 v250, s[72:75], s69 offen lds
    s_add_u32 m0, s70, 41984
    s_nop 0
    buffer_load_dwordx4 v251, s[72:75], s69 offen lds
    s_add_u32 m0, s70, 43008
    s_nop 0
    buffer_load_dwordx4 v252, s[72:75], s69 offen lds
    s_add_u32 m0, s70, 44032
    s_nop 0
    buffer_load_dwordx4 v253, s[72:75], s69 offen lds
    s_add_u32 m0, s70, 45056
    s_nop 0
    buffer_load_dwordx4 v254, s[72:75], s69 offen lds
    s_add_u32 s69, s69, 128
    s_cmp_eq_u32 s69, 1280
    s_cselect_b32 s69, 0, s69
    s_waitcnt vmcnt(15)
    v_mov_b32 v180, 159440
    v_mov_b32 v181, 1
    s_mov_b64 exec, 1
    ds_add_u32 v180, v181
    s_mov_b64 exec, -1
    v_and_b32 v2, 15, v0
    v_lshrrev_b32 v3, 4, v0
    v_lshlrev_b32 v4, 3, v0
    v_lshlrev_b32 v5, 4, v0
    s_and_b32 s10, s6, 1
    v_lshl_add_u32 v9, v3, 2, s10
    v_cvt_f32_u32 v9, v9
    s_cmp_lt_u32 s6, 2
    s_cselect_b32 s10, 0, 0x3e800000
    s_cmp_eq_u32 s6, 2
    s_cselect_b32 s14, 16, 0
    v_cmp_gt_u32 vcc, s14, v0
    s_bfe_u32 s9, s5, 0x10002
    s_mul_i32 s9, s9, 80
    s_add_u32 s9, s9, 64
    s_mov_b32 s8, s60
    s_lshl1_add_u32 s14, s8, 1
    v_lshl_add_u32 v7, v2, 1, s14
    v_cvt_f32_u32 v7, v7
    v_mul_f32 v7, 0x3a4ccccd, v7
    v_fma_f32 v8, v7, v9, s10
    v_mul_f32 v164, 0x42800000, v7
    v_cos_f32 v164, v164
    v_fmamk_f32 v10, v7, 0x43a00000, v8
    v_cndmask_b32 v10, v8, v10, vcc
    v_cos_f32 v10, v10
    v_fmamk_f32 v132, v7, 0x00000000, v8
    v_fmamk_f32 v133, v7, 0x40000000, v8
    v_fmamk_f32 v134, v7, 0x41800000, v8
    v_fmamk_f32 v135, v7, 0x41900000, v8
    v_fmamk_f32 v136, v7, 0x42000000, v8
    v_fmamk_f32 v137, v7, 0x42080000, v8
    v_fmamk_f32 v138, v7, 0x42400000, v8
    v_fmamk_f32 v139, v7, 0x42480000, v8
    v_add_f32 v164, v164, v164
    v_cos_f32 v132, v132
    v_cos_f32 v133, v133
    v_cos_f32 v134, v134
    v_cos_f32 v135, v135
    v_cos_f32 v136, v136
    v_cos_f32 v137, v137
    v_cos_f32 v138, v138
    v_cos_f32 v139, v139
    v_fmamk_f32 v140, v7, 0x42800000, v8
    v_fmamk_f32 v141, v7, 0x42840000, v8
    v_fmamk_f32 v142, v7, 0x42a00000, v8
    v_fmamk_f32 v143, v7, 0x42a40000, v8
    v_fmamk_f32 v144, v7, 0x42c00000, v8
    v_fmamk_f32 v145, v7, 0x42c40000, v8
    v_fmamk_f32 v146, v7, 0x42e00000, v8
    v_fmamk_f32 v147, v7, 0x42e40000, v8
    v_cos_f32 v140, v140
    v_cos_f32 v141, v141
    v_cos_f32 v142, v142
    v_cos_f32 v143, v143
    v_cos_f32 v144, v144
    v_cos_f32 v145, v145
    v_cos_f32 v146, v146
    v_cos_f32 v147, v147
    v_cvt_pk_bf16_f32 v92, v10, v133
    v_cvt_pk_bf16_f32 v93, v134, v135
    v_cvt_pk_bf16_f32 v94, v136, v137
    v_cvt_pk_bf16_f32 v95, v138, v139
    v_cvt_pk_bf16_f32 v96, v140, v141
    v_cvt_pk_bf16_f32 v97, v142, v143
    v_cvt_pk_bf16_f32 v98, v144, v145
    v_cvt_pk_bf16_f32 v99, v146, v147
    v_fma_f32 v132, v140, v164, -v132
    v_fma_f32 v133, v141, v164, -v133
    v_fma_f32 v134, v142, v164, -v134
    v_fma_f32 v135, v143, v164, -v135
    v_fma_f32 v136, v144, v164, -v136
    v_fma_f32 v137, v145, v164, -v137
    v_fma_f32 v138, v146, v164, -v138
    v_fma_f32 v139, v147, v164, -v139
    v_cvt_pk_bf16_f32 v100, v132, v133
    v_cvt_pk_bf16_f32 v101, v134, v135
    v_cvt_pk_bf16_f32 v102, v136, v137
    v_cvt_pk_bf16_f32 v103, v138, v139
    v_fma_f32 v140, v132, v164, -v140
    v_fma_f32 v141, v133, v164, -v141
    v_fma_f32 v142, v134, v164, -v142
    v_fma_f32 v143, v135, v164, -v143
    v_fma_f32 v144, v136, v164, -v144
    v_fma_f32 v145, v137, v164, -v145
    v_fma_f32 v146, v138, v164, -v146
    v_fma_f32 v147, v139, v164, -v147
    v_cvt_pk_bf16_f32 v104, v140, v141
    v_cvt_pk_bf16_f32 v105, v142, v143
    v_cvt_pk_bf16_f32 v106, v144, v145
    v_cvt_pk_bf16_f32 v107, v146, v147
    v_fma_f32 v132, v140, v164, -v132
    v_fma_f32 v133, v141, v164, -v133
    v_fma_f32 v134, v142, v164, -v134
    v_fma_f32 v135, v143, v164, -v135
    v_fma_f32 v136, v144, v164, -v136
    v_fma_f32 v137, v145, v164, -v137
    v_fma_f32 v138, v146, v164, -v138
    v_fma_f32 v139, v147, v164, -v139
    v_cvt_pk_bf16_f32 v108, v132, v133
    v_cvt_pk_bf16_f32 v109, v134, v135
    v_cvt_pk_bf16_f32 v110, v136, v137
    v_cvt_pk_bf16_f32 v111, v138, v139
    s_waitcnt vmcnt(0)
    v_mov_b32 v180, 159588
    v_mov_b32 v181, 1
    s_mov_b64 exec, 1
    ds_add_u32 v180, v181
    s_mov_b64 exec, -1
    s_lshl1_add_u32 s14, s9, 1
    v_lshl_add_u32 v7, v2, 1, s14
    v_cvt_f32_u32 v7, v7
    v_mul_f32 v7, 0x3a4ccccd, v7
    v_fma_f32 v8, v7, v9, s10
    v_mul_f32 v164, 0x42800000, v7
    v_cos_f32 v164, v164
    v_fmamk_f32 v10, v7, 0x43a00000, v8
    v_cndmask_b32 v10, v8, v10, vcc
    v_cos_f32 v10, v10
    v_fmamk_f32 v132, v7, 0x00000000, v8
    v_fmamk_f32 v133, v7, 0x40000000, v8
    v_fmamk_f32 v134, v7, 0x41800000, v8
    v_fmamk_f32 v135, v7, 0x41900000, v8
    v_fmamk_f32 v136, v7, 0x42000000, v8
    v_fmamk_f32 v137, v7, 0x42080000, v8
    v_fmamk_f32 v138, v7, 0x42400000, v8
    v_fmamk_f32 v139, v7, 0x42480000, v8
    v_add_f32 v164, v164, v164
    v_cos_f32 v132, v132
    v_cos_f32 v133, v133
    v_cos_f32 v134, v134
    v_cos_f32 v135, v135
    v_cos_f32 v136, v136
    v_cos_f32 v137, v137
    v_cos_f32 v138, v138
    v_cos_f32 v139, v139
    v_fmamk_f32 v140, v7, 0x42800000, v8
    v_fmamk_f32 v141, v7, 0x42840000, v8
    v_fmamk_f32 v142, v7, 0x42a00000, v8
    v_fmamk_f32 v143, v7, 0x42a40000, v8
    v_fmamk_f32 v144, v7, 0x42c00000, v8
    v_fmamk_f32 v145, v7, 0x42c40000, v8
    v_fmamk_f32 v146, v7, 0x42e00000, v8
    v_fmamk_f32 v147, v7, 0x42e40000, v8
    v_cos_f32 v140, v140
    v_cos_f32 v141, v141
    v_cos_f32 v142, v142
    v_cos_f32 v143, v143
    v_cos_f32 v144, v144
    v_cos_f32 v145, v145
    v_cos_f32 v146, v146
    v_cos_f32 v147, v147
    v_cvt_pk_bf16_f32 v112, v10, v133
    v_cvt_pk_bf16_f32 v113, v134, v135
    v_cvt_pk_bf16_f32 v114, v136, v137
    v_cvt_pk_bf16_f32 v115, v138, v139
    v_cvt_pk_bf16_f32 v116, v140, v141
    v_cvt_pk_bf16_f32 v117, v142, v143
    v_cvt_pk_bf16_f32 v118, v144, v145
    v_cvt_pk_bf16_f32 v119, v146, v147
    v_fma_f32 v132, v140, v164, -v132
    v_fma_f32 v133, v141, v164, -v133
    v_fma_f32 v134, v142, v164, -v134
    v_fma_f32 v135, v143, v164, -v135
    v_fma_f32 v136, v144, v164, -v136
    v_fma_f32 v137, v145, v164, -v137
    v_fma_f32 v138, v146, v164, -v138
    v_fma_f32 v139, v147, v164, -v139
    v_cvt_pk_bf16_f32 v120, v132, v133
    v_cvt_pk_bf16_f32 v121, v134, v135
    v_cvt_pk_bf16_f32 v122, v136, v137
    v_cvt_pk_bf16_f32 v123, v138, v139
    v_fma_f32 v140, v132, v164, -v140
    v_fma_f32 v141, v133, v164, -v141
    v_fma_f32 v142, v134, v164, -v142
    v_fma_f32 v143, v135, v164, -v143
    v_fma_f32 v144, v136, v164, -v144
    v_fma_f32 v145, v137, v164, -v145
    v_fma_f32 v146, v138, v164, -v146
    v_fma_f32 v147, v139, v164, -v147
    v_cvt_pk_bf16_f32 v124, v140, v141
    v_cvt_pk_bf16_f32 v125, v142, v143
    v_cvt_pk_bf16_f32 v126, v144, v145
    v_cvt_pk_bf16_f32 v127, v146, v147
    v_fma_f32 v132, v140, v164, -v132
    v_fma_f32 v133, v141, v164, -v133
    v_fma_f32 v134, v142, v164, -v134
    v_fma_f32 v135, v143, v164, -v135
    v_fma_f32 v136, v144, v164, -v136
    v_fma_f32 v137, v145, v164, -v137
    v_fma_f32 v138, v146, v164, -v138
    v_fma_f32 v139, v147, v164, -v139
    v_cvt_pk_bf16_f32 v128, v132, v133
    v_cvt_pk_bf16_f32 v129, v134, v135
    v_cvt_pk_bf16_f32 v130, v136, v137
    v_cvt_pk_bf16_f32 v131, v138, v139
    s_lshl2_add_u32 s10, s65, s6
    s_mul_i32 s10, s10, 20480
    s_add_u32 s10, s10, 5472256
    s_lshr_b32 s11, s65, 1
    s_lshl_b32 s11, s11, 9
    s_and_b32 s12, s65, 1
    s_lshl_b32 s12, s12, 6
    s_add_u32 s11, s11, s12
    s_add_u32 s11, s11, 49152
    v_lshlrev_b32 v6, 2, v2
    v_lshlrev_b32 v4, 7, v0
    v_and_b32 v11, 31, v0
    v_add_lshl_u32 v11, v11, 64, 7
    s_mov_b32 s52, 0x05040100
    s_mov_b32 s53, 0x07060302
    s_cmp_lg_u32 s3, 4
    s_cbranch_scc1 L_zspin
    s_mov_b32 s15, 0x20000
    s_mov_b32 s1, 16384
L_poll19:
    buffer_load_dword v7, v4, s[56:59], s1 offen sc1
    buffer_load_dword v8, v11, s[56:59], s1 offen sc1
    s_waitcnt vmcnt(0)
    v_xor_b32 v7, s68, v7
    v_xor_b32 v8, s68, v8
    v_or_b32 v7, v7, v8
    v_cmp_ne_u32 vcc, 0, v7
    s_cbranch_vccz L_poll19_ok
    s_sleep 2
    s_sub_u32 s15, s15, 1
    s_cbranch_scc0 L_poll19
L_poll19_ok:
    v_mov_b32 v180, 159596
    v_mov_b32 v181, 1
    s_mov_b64 exec, 1
    ds_add_u32 v180, v181
    s_mov_b64 exec, -1
L_zspin:
    v_mov_b32 v180, 159596
    s_mov_b32 s15, 0x800000
L_lw20:
    ds_read_b32 v181, v180
    s_waitcnt lgkmcnt(0)
    v_readfirstlane_b32 s0, v181
    s_cmp_ge_u32 s0, 1
    s_cbranch_scc1 L_lw20_ok
    s_sub_u32 s15, s15, 1
    s_cbranch_scc0 L_lw20
L_lw20_ok:
    buffer_load_dwordx4 v[12:15], v5, s[56:59], s10 offen offset:0 sc1
    buffer_load_dwordx4 v[16:19], v5, s[56:59], s10 offen offset:1024 sc1
    buffer_load_dwordx4 v[20:23], v5, s[56:59], s10 offen offset:2048 sc1
    buffer_load_dwordx4 v[24:27], v5, s[56:59], s10 offen offset:3072 sc1
    s_add_u32 s10, s10, 4096
    buffer_load_dwordx4 v[28:31], v5, s[56:59], s10 offen offset:0 sc1
    buffer_load_dwordx4 v[32:35], v5, s[56:59], s10 offen offset:1024 sc1
    buffer_load_dwordx4 v[36:39], v5, s[56:59], s10 offen offset:2048 sc1
    buffer_load_dwordx4 v[40:43], v5, s[56:59], s10 offen offset:3072 sc1
    s_add_u32 s10, s10, 4096
    buffer_load_dwordx4 v[44:47], v5, s[56:59], s10 offen offset:0 sc1
    buffer_load_dwordx4 v[48:51], v5, s[56:59], s10 offen offset:1024 sc1
    buffer_load_dwordx4 v[52:55], v5, s[56:59], s10 offen offset:2048 sc1
    buffer_load_dwordx4 v[56:59], v5, s[56:59], s10 offen offset:3072 sc1
    s_add_u32 s10, s10, 4096
    buffer_load_dwordx4 v[60:63], v5, s[56:59], s10 offen offset:0 sc1
    buffer_load_dwordx4 v[64:67], v5, s[56:59], s10 offen offset:1024 sc1
    buffer_load_dwordx4 v[68:71], v5, s[56:59], s10 offen offset:2048 sc1
    buffer_load_dwordx4 v[72:75], v5, s[56:59], s10 offen offset:3072 sc1
    s_add_u32 s10, s10, 4096
    buffer_load_dwordx4 v[76:79], v5, s[56:59], s10 offen offset:0 sc1
    buffer_load_dwordx4 v[80:83], v5, s[56:59], s10 offen offset:1024 sc1
    buffer_load_dwordx4 v[84:87], v5, s[56:59], s10 offen offset:2048 sc1
    buffer_load_dwordx4 v[88:91], v5, s[56:59], s10 offen offset:3072 sc1
    buffer_load_dword v180, v6, s[56:59], s11 offen offset:0 sc1
    buffer_load_dword v181, v6, s[56:59], s11 offen offset:128 sc1
    buffer_load_dword v182, v6, s[56:59], s11 offen offset:256 sc1
    buffer_load_dword v183, v6, s[56:59], s11 offen offset:384 sc1
    s_waitcnt vmcnt(20)
    v_perm_b32 v164, v14, v12, s52
    v_perm_b32 v165, v18, v16, s52
    v_perm_b32 v166, v22, v20, s52
    v_perm_b32 v167, v26, v24, s52
    v_perm_b32 v168, v14, v12, s53
    v_perm_b32 v169, v18, v16, s53
    v_perm_b32 v170, v22, v20, s53
    v_perm_b32 v171, v26, v24, s53
    v_perm_b32 v172, v15, v13, s52
    v_perm_b32 v173, v19, v17, s52
    v_perm_b32 v174, v23, v21, s52
    v_perm_b32 v175, v27, v25, s52
    v_perm_b32 v176, v15, v13, s53
    v_perm_b32 v177, v19, v17, s53
    v_perm_b32 v178, v23, v21, s53
    v_perm_b32 v179, v27, v25, s53
    v_mfma_f32_16x16x32_bf16 v[132:135], v[92:95], v[164:167], 0
    v_mfma_f32_16x16x32_bf16 v[136:139], v[112:115], v[164:167], 0
    v_mfma_f32_16x16x32_bf16 v[140:143], v[92:95], v[168:171], 0
    v_mfma_f32_16x16x32_bf16 v[144:147], v[112:115], v[168:171], 0
    v_mfma_f32_16x16x32_bf16 v[148:151], v[92:95], v[172:175], 0
    v_mfma_f32_16x16x32_bf16 v[152:155], v[112:115], v[172:175], 0
    v_mfma_f32_16x16x32_bf16 v[156:159], v[92:95], v[176:179], 0
    v_mfma_f32_16x16x32_bf16 v[160:163], v[112:115], v[176:179], 0
    s_waitcnt vmcnt(16)
    v_perm_b32 v164, v30, v28, s52
    v_perm_b32 v165, v34, v32, s52
    v_perm_b32 v166, v38, v36, s52
    v_perm_b32 v167, v42, v40, s52
    v_perm_b32 v168, v30, v28, s53
    v_perm_b32 v169, v34, v32, s53
    v_perm_b32 v170, v38, v36, s53
    v_perm_b32 v171, v42, v40, s53
    v_perm_b32 v172, v31, v29, s52
    v_perm_b32 v173, v35, v33, s52
    v_perm_b32 v174, v39, v37, s52
    v_perm_b32 v175, v43, v41, s52
    v_perm_b32 v176, v31, v29, s53
    v_perm_b32 v177, v35, v33, s53
    v_perm_b32 v178, v39, v37, s53
    v_perm_b32 v179, v43, v41, s53
    v_mfma_f32_16x16x32_bf16 v[132:135], v[96:99], v[164:167], v[132:135]
    v_mfma_f32_16x16x32_bf16 v[136:139], v[116:119], v[164:167], v[136:139]
    v_mfma_f32_16x16x32_bf16 v[140:143], v[96:99], v[168:171], v[140:143]
    v_mfma_f32_16x16x32_bf16 v[144:147], v[116:119], v[168:171], v[144:147]
    v_mfma_f32_16x16x32_bf16 v[148:151], v[96:99], v[172:175], v[148:151]
    v_mfma_f32_16x16x32_bf16 v[152:155], v[116:119], v[172:175], v[152:155]
    v_mfma_f32_16x16x32_bf16 v[156:159], v[96:99], v[176:179], v[156:159]
    v_mfma_f32_16x16x32_bf16 v[160:163], v[116:119], v[176:179], v[160:163]
    s_waitcnt vmcnt(12)
    v_perm_b32 v164, v46, v44, s52
    v_perm_b32 v165, v50, v48, s52
    v_perm_b32 v166, v54, v52, s52
    v_perm_b32 v167, v58, v56, s52
    v_perm_b32 v168, v46, v44, s53
    v_perm_b32 v169, v50, v48, s53
    v_perm_b32 v170, v54, v52, s53
    v_perm_b32 v171, v58, v56, s53
    v_perm_b32 v172, v47, v45, s52
    v_perm_b32 v173, v51, v49, s52
    v_perm_b32 v174, v55, v53, s52
    v_perm_b32 v175, v59, v57, s52
    v_perm_b32 v176, v47, v45, s53
    v_perm_b32 v177, v51, v49, s53
    v_perm_b32 v178, v55, v53, s53
    v_perm_b32 v179, v59, v57, s53
    v_mfma_f32_16x16x32_bf16 v[132:135], v[100:103], v[164:167], v[132:135]
    v_mfma_f32_16x16x32_bf16 v[136:139], v[120:123], v[164:167], v[136:139]
    v_mfma_f32_16x16x32_bf16 v[140:143], v[100:103], v[168:171], v[140:143]
    v_mfma_f32_16x16x32_bf16 v[144:147], v[120:123], v[168:171], v[144:147]
    v_mfma_f32_16x16x32_bf16 v[148:151], v[100:103], v[172:175], v[148:151]
    v_mfma_f32_16x16x32_bf16 v[152:155], v[120:123], v[172:175], v[152:155]
    v_mfma_f32_16x16x32_bf16 v[156:159], v[100:103], v[176:179], v[156:159]
    v_mfma_f32_16x16x32_bf16 v[160:163], v[120:123], v[176:179], v[160:163]
    s_waitcnt vmcnt(8)
    v_perm_b32 v164, v62, v60, s52
    v_perm_b32 v165, v66, v64, s52
    v_perm_b32 v166, v70, v68, s52
    v_perm_b32 v167, v74, v72, s52
    v_perm_b32 v168, v62, v60, s53
    v_perm_b32 v169, v66, v64, s53
    v_perm_b32 v170, v70, v68, s53
    v_perm_b32 v171, v74, v72, s53
    v_perm_b32 v172, v63, v61, s52
    v_perm_b32 v173, v67, v65, s52
    v_perm_b32 v174, v71, v69, s52
    v_perm_b32 v175, v75, v73, s52
    v_perm_b32 v176, v63, v61, s53
    v_perm_b32 v177, v67, v65, s53
    v_perm_b32 v178, v71, v69, s53
    v_perm_b32 v179, v75, v73, s53
    v_mfma_f32_16x16x32_bf16 v[132:135], v[104:107], v[164:167], v[132:135]
    v_mfma_f32_16x16x32_bf16 v[136:139], v[124:127], v[164:167], v[136:139]
    v_mfma_f32_16x16x32_bf16 v[140:143], v[104:107], v[168:171], v[140:143]
    v_mfma_f32_16x16x32_bf16 v[144:147], v[124:127], v[168:171], v[144:147]
    v_mfma_f32_16x16x32_bf16 v[148:151], v[104:107], v[172:175], v[148:151]
    v_mfma_f32_16x16x32_bf16 v[152:155], v[124:127], v[172:175], v[152:155]
    v_mfma_f32_16x16x32_bf16 v[156:159], v[104:107], v[176:179], v[156:159]
    v_mfma_f32_16x16x32_bf16 v[160:163], v[124:127], v[176:179], v[160:163]
    s_waitcnt vmcnt(4)
    v_perm_b32 v164, v78, v76, s52
    v_perm_b32 v165, v82, v80, s52
    v_perm_b32 v166, v86, v84, s52
    v_perm_b32 v167, v90, v88, s52
    v_perm_b32 v168, v78, v76, s53
    v_perm_b32 v169, v82, v80, s53
    v_perm_b32 v170, v86, v84, s53
    v_perm_b32 v171, v90, v88, s53
    v_perm_b32 v172, v79, v77, s52
    v_perm_b32 v173, v83, v81, s52
    v_perm_b32 v174, v87, v85, s52
    v_perm_b32 v175, v91, v89, s52
    v_perm_b32 v176, v79, v77, s53
    v_perm_b32 v177, v83, v81, s53
    v_perm_b32 v178, v87, v85, s53
    v_perm_b32 v179, v91, v89, s53
    v_mfma_f32_16x16x32_bf16 v[132:135], v[108:111], v[164:167], v[132:135]
    v_mfma_f32_16x16x32_bf16 v[136:139], v[128:131], v[164:167], v[136:139]
    v_mfma_f32_16x16x32_bf16 v[140:143], v[108:111], v[168:171], v[140:143]
    v_mfma_f32_16x16x32_bf16 v[144:147], v[128:131], v[168:171], v[144:147]
    v_mfma_f32_16x16x32_bf16 v[148:151], v[108:111], v[172:175], v[148:151]
    v_mfma_f32_16x16x32_bf16 v[152:155], v[128:131], v[172:175], v[152:155]
    v_mfma_f32_16x16x32_bf16 v[156:159], v[108:111], v[176:179], v[156:159]
    v_mfma_f32_16x16x32_bf16 v[160:163], v[128:131], v[176:179], v[160:163]
    s_lshl_b32 s10, s6, 13
    s_add_u32 s10, s10, 61440
    v_lshl_add_u32 v4, v3, 2, v2
    v_and_b32 v4, 15, v4
    v_lshlrev_b32 v4, 4, v4
    v_lshl_add_u32 v4, v3, 8, v4
    v_add_u32 v4, s10, v4
    v_mov_b32 v7, 159592
    s_mov_b32 s15, 0x800000
L_lw21:
    ds_read_b32 v8, v7
    s_waitcnt lgkmcnt(0)
    v_readfirstlane_b32 s0, v8
    s_cmp_ge_u32 s0, 4
    s_cbranch_scc1 L_lw21_ok
    s_sub_u32 s15, s15, 1
    s_cbranch_scc0 L_lw21
L_lw21_ok:
    s_waitcnt vmcnt(0)
    v_add_u32 v6, 159744, v6
    v_sub_f32 v164, 1.0, v180
    v_cvt_pk_bf16_f32 v164, v164, v164
    v_lshlrev_b32 v164, 16, v164
    ds_write_b32 v6, v164 offset:0
    v_sub_f32 v165, 1.0, v181
    v_cvt_pk_bf16_f32 v165, v165, v165
    v_lshlrev_b32 v165, 16, v165
    ds_write_b32 v6, v165 offset:64
    v_sub_f32 v166, 1.0, v182
    v_cvt_pk_bf16_f32 v166, v166, v166
    v_lshlrev_b32 v166, 16, v166
    ds_write_b32 v6, v166 offset:128
    v_sub_f32 v167, 1.0, v183
    v_cvt_pk_bf16_f32 v167, v167, v167
    v_lshlrev_b32 v167, 16, v167
    ds_write_b32 v6, v167 offset:192
    v_mul_f32 v132, v132, v180
    v_mul_f32 v133, v133, v180
    v_mul_f32 v134, v134, v180
    v_mul_f32 v135, v135, v180
    v_mul_f32 v136, v136, v180
    v_mul_f32 v137, v137, v180
    v_mul_f32 v138, v138, v180
    v_mul_f32 v139, v139, v180
    ds_write_b128 v4, v[132:135] offset:0
    ds_write_b128 v4, v[136:139] offset:1024
    v_mul_f32 v140, v140, v181
    v_mul_f32 v141, v141, v181
    v_mul_f32 v142, v142, v181
    v_mul_f32 v143, v143, v181
    v_mul_f32 v144, v144, v181
    v_mul_f32 v145, v145, v181
    v_mul_f32 v146, v146, v181
    v_mul_f32 v147, v147, v181
    ds_write_b128 v4, v[140:143] offset:2048
    ds_write_b128 v4, v[144:147] offset:3072
    v_mul_f32 v148, v148, v182
    v_mul_f32 v149, v149, v182
    v_mul_f32 v150, v150, v182
    v_mul_f32 v151, v151, v182
    v_mul_f32 v152, v152, v182
    v_mul_f32 v153, v153, v182
    v_mul_f32 v154, v154, v182
    v_mul_f32 v155, v155, v182
    ds_write_b128 v4, v[148:151] offset:4096
    ds_write_b128 v4, v[152:155] offset:5120
    v_mul_f32 v156, v156, v183
    v_mul_f32 v157, v157, v183
    v_mul_f32 v158, v158, v183
    v_mul_f32 v159, v159, v183
    v_mul_f32 v160, v160, v183
    v_mul_f32 v161, v161, v183
    v_mul_f32 v162, v162, v183
    v_mul_f32 v163, v163, v183
    ds_write_b128 v4, v[156:159] offset:6144
    ds_write_b128 v4, v[160:163] offset:7168
    s_waitcnt lgkmcnt(0)
    s_barrier
    s_cmp_lg_u32 s2, 0
    s_cbranch_scc1 L_P3l_end
    s_cmp_lg_u32 s3, 7
    s_cbranch_scc1 L_P3l_end
    v_lshlrev_b32 v4, 3, v0
    v_add_u32 v164, 36864, v4
    v_add_u32 v165, 37376, v4
    v_add_u32 v166, 37888, v4
    v_add_u32 v167, 38400, v4
    s_mov_b32 s15, 0x20000
    s_mov_b32 s1, 0
L_poll22:
    buffer_load_dword v168, v164, s[56:59], s1 offen sc1
    buffer_load_dword v169, v165, s[56:59], s1 offen sc1
    buffer_load_dword v170, v166, s[56:59], s1 offen sc1
    buffer_load_dword v171, v167, s[56:59], s1 offen sc1
    s_waitcnt vmcnt(0)
    v_xor_b32 v168, s68, v168
    v_xor_b32 v169, s68, v169
    v_xor_b32 v170, s68, v170
    v_xor_b32 v171, s68, v171
    v_or_b32 v168, v168, v169
    v_or_b32 v168, v168, v170
    v_or_b32 v168, v168, v171
    v_cmp_ne_u32 vcc, 0, v168
    s_cbranch_vccz L_poll22_ok
    s_sleep 2
    s_sub_u32 s15, s15, 1
    s_cbranch_scc0 L_poll22
L_poll22_ok:
    v_mov_b32 v7, s68
    v_mov_b32 v4, 40960
    buffer_store_dword v7, v4, s[56:59], 0 offen sc1
L_P3l_end:
    s_endpgm
L_code_end:
.section .rodata,"a"
.p2align 6
.amdhsa_kernel gated_mix__spectral_gfnet__ssm_conv_s5__prompt_kernel
  .amdhsa_next_free_vgpr 256
  .amdhsa_next_free_sgpr 102
  .amdhsa_accum_offset 256
  .amdhsa_group_segment_fixed_size 0
  .amdhsa_kernarg_size 128
  .amdhsa_user_sgpr_count 2
  .amdhsa_user_sgpr_kernarg_segment_ptr 1
  .amdhsa_system_sgpr_workgroup_id_x 1
.end_amdhsa_kernel
```
